```python
import torch

def _softmax(x, axis=-1):
    return torch.softmax(x, dim=axis)
def _gelu(x):
    return torch.nn.functional.gelu(x, approximate="tanh")
def _silu(x):
    return torch.nn.functional.silu(x)
def _sigmoid(x):
    return torch.sigmoid(x)
def _layernorm(x, axis=-1, eps=1e-5):
    m = x.mean(dim=axis, keepdim=True)
    v = x.var(dim=axis, keepdim=True, unbiased=False)
    return (x - m) / torch.sqrt(v + eps)
def _scatter_add(tgt, idx, src, axis=0):
    return tgt.clone().index_add_(axis, idx, src)
def _segment_sum(src, seg, n):
    out = torch.zeros((n,) + src.shape[1:], dtype=src.dtype)
    return out.index_add_(0, seg, src)
def _pad(x, pw):
    flat = tuple(v for pair in reversed(pw) for v in pair)
    return torch.nn.functional.pad(x, flat)

kernel_name = 'recurrent_scan__gqa_block_cached__glu_gated_glu__decode'

def setup_inputs():

    _w = (lambda a: (lambda t: t.to(torch.bfloat16) if t.is_floating_point() else t)(torch.as_tensor(a)))
    def _A_setup():
        B, Sq, D = 1, 1, 576
        Hq, Hkv, Sk, Dh = 32, 16, 65536, 128
        assert Hq % Hkv == 0, (Hq, Hkv)
        return {
            "x": _w((lambda *s: torch.randn(*s, dtype=torch.bfloat16) * 0.05)(B, Sq, D)),
            "k_cache": _w((lambda *s: torch.randn(*s, dtype=torch.bfloat16) * 1.6)(B, Hkv, Sk, Dh)),
            "v_cache": _w((lambda *s: torch.randn(*s, dtype=torch.bfloat16) * 0.8)(B, Hkv, Sk, Dh)),
            "wq": _w((lambda *s: torch.randn(*s, dtype=torch.bfloat16) * 1.6)(D, Hq * Dh) * (D ** -0.5)),
            "wo": _w((lambda *s: torch.randn(*s, dtype=torch.bfloat16) * 0.8)(Hq * Dh, D) * ((Hq * Dh) ** -0.5)),
        }
    _A_in = _A_setup()

    def _B_setup():
        B, S, D, F = 1, 1, 576, 4608
        return {
            "x": _w((lambda *s: torch.randn(*s, dtype=torch.bfloat16) * 0.05)(B, S, D)),
            "w_gate": _w((lambda *s: torch.randn(*s, dtype=torch.bfloat16) * 0.8)(D, F)),
            "w_up": _w((lambda *s: torch.randn(*s, dtype=torch.bfloat16) * 0.2)(D, F)),
            "w_down": _w((lambda *s: torch.randn(*s, dtype=torch.bfloat16) * 0.2)(F, D)),
        }
    _B_in = _B_setup()

    return {
        "A_x": _A_in["x"],
        "A_k_cache": _A_in["k_cache"],
        "A_v_cache": _A_in["v_cache"],
        "A_wq": _A_in["wq"],
        "A_wo": _A_in["wo"],
        "B_x": _B_in["x"],
        "B_w_gate": _B_in["w_gate"],
        "B_w_up": _B_in["w_up"],
        "B_w_down": _B_in["w_down"],
    }

def reference(A_x, A_k_cache, A_v_cache, A_wq, A_wo, B_x, B_w_gate, B_w_up, B_w_down):
    def _A_ref(x, k_cache, v_cache, wq, wo):
        B, Sq, D = x.shape
        Hq, Dh = 32, 128
        Hkv = k_cache.shape[1]
        rep = Hq // Hkv
        q = (lambda x, *d: x.permute(*d))((x @ wq).reshape(B, Sq, Hq, Dh), 0, 2, 1, 3)
        k = (lambda x, n, axis: torch.repeat_interleave(x, n, dim=axis))(k_cache, rep, axis=1)
        v = (lambda x, n, axis: torch.repeat_interleave(x, n, dim=axis))(v_cache, rep, axis=1)
        scores = torch.einsum("bhqd,bhkd->bhqk", q, k) * (Dh ** -0.5)
        p = _softmax(scores, axis=-1)
        o = torch.einsum("bhqk,bhkd->bhqd", p, v)
        return (lambda x, *d: x.permute(*d))(o, 0, 2, 1, 3).reshape(B, Sq, Hq * Dh) @ wo

    def _B_ref(x, w_gate, w_up, w_down):
        g = torch.einsum("bsd,df->bsf", x, w_gate)
        u = torch.einsum("bsd,df->bsf", x, w_up)
        h = _sigmoid(g) * u
        return torch.einsum("bsf,fd->bsd", h, w_down)

    x = A_x
    xn = _layernorm(x, axis=-1)
    s = _A_ref(xn, A_k_cache, A_v_cache, A_wq, A_wo)
    g = _silu(_B_ref(xn, B_w_gate, B_w_up, B_w_down))
    return x + s * g
```

```asm
; @launch grid=(256,1,1) block=(512,1,1) lds=25600
.amdgcn_target "amdgcn-amd-amdhsa--gfx950"
    .text
    .globl recurrent_scan__gqa_block_cached__glu_gated_glu__decode_kernel
    .p2align 8
    .type recurrent_scan__gqa_block_cached__glu_gated_glu__decode_kernel,@function
recurrent_scan__gqa_block_cached__glu_gated_glu__decode_kernel:
    s_cmp_ge_u32 s2, 256
    s_cbranch_scc1 L_end
    s_load_dwordx16 s[4:19], s[0:1], 0
    s_load_dwordx8 s[20:27], s[0:1], 64
    v_lshrrev_b32 v2, 6, v0
    v_and_b32 v1, 63, v0
    s_and_b32 s28, s2, 7
    v_readfirstlane_b32 s3, v2
    s_lshl_b32 s28, s28, 1
    s_bfe_u32 s29, s2, 0x10003
    s_or_b32 s28, s28, s29
    s_lshr_b32 s29, s2, 4
    s_lshl_b32 s30, s28, 4
    s_or_b32 s30, s30, s29
    s_sub_u32 s98, s29, 8
    s_cselect_b32 s98, -1, s98
    s_sub_u32 s99, s29, 7
    s_cselect_b32 s99, -1, s99
    s_cmp_lt_u32 s3, 4
    s_cbranch_scc1 L_helper
    v_and_b32 v2, 15, v1
    v_lshrrev_b32 v3, 4, v1
    v_and_b32 v7, 3, v1
    v_bfe_u32 v11, v1, 2, 2
    v_and_b32 v242, 1, v11
    v_lshrrev_b32 v243, 1, v11
    v_lshlrev_b32 v4, 12, v242
    v_lshl_add_u32 v4, v243, 14, v4
    v_lshl_add_u32 v6, v3, 6, v4
    v_lshl_add_u32 v6, v7, 4, v6
    v_lshl_add_u32 v4, v7, 8, v4
    v_lshl_add_u32 v4, v3, 4, v4
    s_sub_u32 s31, s3, 4
    s_lshr_b32 s60, s30, 1
    s_lshl_b32 s60, s60, 21
    s_and_b32 s61, s30, 1
    s_lshl_b32 s61, s61, 11
    s_add_u32 s60, s60, s61
    s_sub_u32 s65, 2097152, s61
    s_mul_i32 s63, s28, 9
    s_add_u32 s63, s63, s29
    s_bfe_u32 s63, s63, 0x30001
    s_cmp_gt_u32 s29, 8
    s_cselect_b32 s63, 0, s63
    s_cmp_eq_u32 s63, 3
    s_cselect_b32 s68, 40, 0
    s_and_b32 s63, s28, 1
    s_lshl_b32 s63, s63, 4
    s_sub_i32 s63, s29, s63
    s_cmp_ge_i32 s63, 14
    s_cselect_b32 s63, 36, 0
    s_add_u32 s68, s68, s63
    s_cmp_lt_u32 s29, 7
    s_cselect_b32 s63, 12, 0
    s_cmp_eq_u32 s29, 7
    s_cselect_b32 s63, 42, s63
    s_cmp_eq_u32 s29, 8
    s_cselect_b32 s63, 52, s63
    s_add_u32 s68, s68, s63
    s_add_u32 s68, s68, 36
    v_mov_b32 v242, 0
    v_mov_b32 v243, 36
    v_mov_b32 v240, 1536
    v_mov_b32 v7, s68
    v_mov_b32 v9, 0xff7fffff
    ds_write_b32 v240, v242
    ds_write_b32 v240, v242 offset:4
    ds_write_b32 v240, v242 offset:8
    ds_write_b32 v240, v243 offset:12
    ds_write_b32 v240, v242 offset:16
    ds_write_b32 v240, v7 offset:56
    ds_write_b32 v240, v242 offset:60
    ds_write_b32 v240, v242 offset:24
    ds_write_b32 v240, v242 offset:28
    ds_write_b32 v240, v242 offset:32
    ds_write_b32 v240, v242 offset:36
    ds_write_b32 v240, v242 offset:40
    ds_write_b32 v240, v242 offset:44
    ds_write_b32 v240, v242 offset:64
    ds_write_b32 v240, v9 offset:48
    ds_write_b32 v240, v9 offset:52
    s_waitcnt lgkmcnt(0)
    s_add_u32 s32, s6, s60
    s_addc_u32 s33, s7, 0
    s_mov_b32 s34, s65
    s_mov_b32 s35, 0x20000
    s_add_u32 s36, s8, s60
    s_addc_u32 s37, s9, 0
    s_mov_b32 s38, s65
    s_mov_b32 s39, 0x20000
    s_and_b32 s50, s31, 0x1
    s_lshl_b32 s51, s50, 15
    s_and_b32 s50, s31, 0xff22
    s_lshl_b32 s50, s50, 12
    s_or_b32 s51, s51, s50
    s_and_b32 s50, s31, 0x4
    s_lshl_b32 s50, s50, 14
    s_or_b32 s51, s51, s50
    s_and_b32 s50, s31, 0x8
    s_lshl_b32 s50, s50, 8
    s_or_b32 s51, s51, s50
    s_and_b32 s50, s31, 0x10
    s_lshl_b32 s50, s50, 6
    s_or_b32 s51, s51, s50
    s_and_b32 s50, s31, 0x40
    s_lshl_b32 s50, s50, 13
    s_or_b32 s51, s51, s50
    s_and_b32 s50, s31, 0x80
    s_lshl_b32 s50, s50, 11
    s_or_b32 s51, s51, s50
    s_mov_b32 s62, s51
    s_and_b32 s63, s62, 1048575
    s_lshr_b32 s50, s63, 11
    s_and_b32 s50, s50, 1
    s_lshl_b32 s50, s50, 20
    s_bitset0_b32 s63, 11
    s_or_b32 s63, s63, s50
    s_barrier
    s_mov_b32 s44, s62
    s_mov_b32 s45, s63
    buffer_load_dwordx4 v[64:67], v6, s[32:35], s63 offen offset:0 nt
    buffer_load_dwordx4 v[68:71], v6, s[32:35], s63 offen offset:256 nt
    buffer_load_dwordx4 v[72:75], v6, s[32:35], s63 offen offset:512 nt
    buffer_load_dwordx4 v[76:79], v6, s[32:35], s63 offen offset:768 nt
    s_or_b32 s40, s44, 0x0
    s_or_b32 s63, s45, 0x10000
    buffer_load_dwordx4 v[80:83], v6, s[32:35], s63 offen offset:0 nt
    buffer_load_dwordx4 v[84:87], v6, s[32:35], s63 offen offset:256 nt
    buffer_load_dwordx4 v[88:91], v6, s[32:35], s63 offen offset:512 nt
    buffer_load_dwordx4 v[92:95], v6, s[32:35], s63 offen offset:768 nt
    s_or_b32 s41, s44, 0x10000
    s_or_b32 s63, s45, 0x100000
    buffer_load_dwordx4 v[96:99], v6, s[32:35], s63 offen offset:0 nt
    buffer_load_dwordx4 v[100:103], v6, s[32:35], s63 offen offset:256 nt
    buffer_load_dwordx4 v[104:107], v6, s[32:35], s63 offen offset:512 nt
    buffer_load_dwordx4 v[108:111], v6, s[32:35], s63 offen offset:768 nt
    s_or_b32 s42, s44, 0x800
    s_or_b32 s63, s45, 0x110000
    buffer_load_dwordx4 v[112:115], v6, s[32:35], s63 offen offset:0 nt
    buffer_load_dwordx4 v[116:119], v6, s[32:35], s63 offen offset:256 nt
    buffer_load_dwordx4 v[120:123], v6, s[32:35], s63 offen offset:512 nt
    buffer_load_dwordx4 v[124:127], v6, s[32:35], s63 offen offset:768 nt
    s_or_b32 s10, s44, 0x10800
    s_branch L_main
L_helper:
    s_setprio 3
    v_lshrrev_b32 v2, 2, v1
    v_and_b32 v3, 3, v1
    s_mul_i32 s31, s3, 144
    v_add_u32 v4, s31, v2
    v_lshlrev_b32 v5, 4, v1
    v_lshlrev_b32 v6, 1, v4
    v_lshlrev_b32 v7, 13, v4
    v_lshl_add_u32 v7, v3, 4, v7
    v_mul_u32_u24 v224, 9216, v4
    v_lshl_add_u32 v224, v3, 4, v224
    s_lshl_b32 s60, s28, 9
    s_lshl_b32 s61, s98, 6
    s_add_u32 s60, s60, s61
    v_mov_b32 v16, 0
    v_mov_b32 v17, 0
    v_mov_b32 v18, 0
    v_mov_b32 v19, 0
    v_mov_b32 v20, 0
    v_mov_b32 v21, 0
    v_mov_b32 v22, 0
    v_mov_b32 v23, 0
    v_mov_b32 v24, 0
    s_waitcnt lgkmcnt(0)
    s_mov_b32 s40, s4
    s_mov_b32 s41, s5
    s_mov_b32 s42, 1152
    s_mov_b32 s43, 0x20000
    s_mov_b32 s32, s10
    s_mov_b32 s33, s11
    s_mov_b32 s34, 4718592
    s_mov_b32 s35, 0x20000
    s_load_dword s97, s[26:27], 32768
    buffer_load_dwordx4 v[8:11], v5, s[40:43], 0 offen
    buffer_load_dwordx4 v[12:15], v5, s[40:43], 0 offen offset:1024
    buffer_load_short_d16_hi v16, v6, s[40:43], 0 offen offset:0
    buffer_load_short_d16_hi v17, v6, s[40:43], 0 offen offset:32
    buffer_load_short_d16_hi v18, v6, s[40:43], 0 offen offset:64
    buffer_load_short_d16_hi v19, v6, s[40:43], 0 offen offset:96
    buffer_load_short_d16_hi v20, v6, s[40:43], 0 offen offset:128
    buffer_load_short_d16_hi v21, v6, s[40:43], 0 offen offset:160
    buffer_load_short_d16_hi v22, v6, s[40:43], 0 offen offset:192
    buffer_load_short_d16_hi v23, v6, s[40:43], 0 offen offset:224
    buffer_load_short_d16_hi v24, v6, s[40:43], 0 offen offset:256
    s_cmp_eq_u32 s98, -1
    s_cbranch_scc1 L_h_noq
    buffer_load_dwordx4 v[44:47], v7, s[32:35], s60 offen
    s_add_u32 s60, s60, 0x20000
    buffer_load_dwordx4 v[48:51], v7, s[32:35], s60 offen
    s_add_u32 s60, s60, 0x20000
    buffer_load_dwordx4 v[52:55], v7, s[32:35], s60 offen
    s_add_u32 s60, s60, 0x20000
    buffer_load_dwordx4 v[56:59], v7, s[32:35], s60 offen
    s_add_u32 s60, s60, 0x20000
    buffer_load_dwordx4 v[60:63], v7, s[32:35], s60 offen
    s_add_u32 s60, s60, 0x20000
    buffer_load_dwordx4 v[64:67], v7, s[32:35], s60 offen
    s_add_u32 s60, s60, 0x20000
    buffer_load_dwordx4 v[68:71], v7, s[32:35], s60 offen
    s_add_u32 s60, s60, 0x20000
    buffer_load_dwordx4 v[72:75], v7, s[32:35], s60 offen
    s_add_u32 s60, s60, 0x20000
    buffer_load_dwordx4 v[76:79], v7, s[32:35], s60 offen
    s_barrier
    s_waitcnt vmcnt(9)
    s_branch L_h_ln
L_h_noq:
    s_barrier
    s_waitcnt vmcnt(0)
L_h_ln:
    s_mov_b32 s52, s26
    s_mov_b32 s53, s27
    s_mov_b32 s54, 1572864
    s_mov_b32 s55, 0x20000
    s_waitcnt lgkmcnt(0)
    s_add_u32 s97, s97, 9
    s_getreg_b32 s63, hwreg(HW_REG_XCC_ID, 0, 3)
    s_and_b32 s96, s97, 0xfff8
    s_or_b32 s96, s96, s63
    s_lshl_b32 s64, s29, 2
    s_add_u32 s64, s64, s3
    s_cmp_lg_u32 s64, 31
    s_cbranch_scc1 L_nohello
    s_mul_i32 s64, s28, 1152
    v_mov_b32 v226, s96
    v_lshlrev_b32 v225, 2, v1
    s_mov_b32 exec_lo, 0xffffffff
    s_mov_b32 exec_hi, 0x0
    buffer_store_dword v226, v225, s[52:55], s64 offen offset:1024 sc1
    s_mov_b64 exec, -1
L_nohello:
    s_mov_b32 s48, s12
    s_mov_b32 s49, s13
    s_mov_b32 s50, 4718592
    s_mov_b32 s51, 0x20000
    s_mov_b32 s44, s20
    s_mov_b32 s45, s21
    s_mov_b32 s46, 5308416
    s_mov_b32 s47, 0x20000
    s_mov_b32 s20, s16
    s_mov_b32 s21, s17
    s_mov_b32 s22, 5308416
    s_mov_b32 s23, 0x20000
    s_mov_b32 s56, s18
    s_mov_b32 s57, s19
    s_mov_b32 s58, 5308416
    s_mov_b32 s59, 0x20000
    v_lshlrev_b32 v228, 16, v8
    v_and_b32 v229, 0xffff0000, v8
    v_lshlrev_b32 v236, 16, v12
    v_and_b32 v237, 0xffff0000, v12
    v_lshlrev_b32 v230, 16, v9
    v_and_b32 v231, 0xffff0000, v9
    v_lshlrev_b32 v238, 16, v13
    v_and_b32 v239, 0xffff0000, v13
    v_lshlrev_b32 v232, 16, v10
    v_and_b32 v233, 0xffff0000, v10
    v_lshlrev_b32 v240, 16, v14
    v_and_b32 v241, 0xffff0000, v14
    v_lshlrev_b32 v234, 16, v11
    v_and_b32 v235, 0xffff0000, v11
    v_lshlrev_b32 v242, 16, v15
    v_and_b32 v243, 0xffff0000, v15
    v_add_f32 v8, v228, v229
    v_add_f32 v9, v230, v231
    v_add_f32 v8, v8, v232
    v_add_f32 v9, v9, v233
    v_add_f32 v8, v8, v234
    v_add_f32 v9, v9, v235
    v_add_f32 v8, v8, v236
    v_add_f32 v9, v9, v237
    v_add_f32 v8, v8, v238
    v_add_f32 v9, v9, v239
    v_add_f32 v8, v8, v240
    v_add_f32 v9, v9, v241
    v_add_f32 v8, v8, v242
    v_add_f32 v9, v9, v243
    v_add_f32 v8, v8, v9
    s_nop 1
    v_add_f32_dpp v8, v8, v8 row_ror:1 row_mask:0xf bank_mask:0xf
    s_nop 1
    v_add_f32_dpp v8, v8, v8 row_ror:2 row_mask:0xf bank_mask:0xf
    s_nop 1
    v_add_f32_dpp v8, v8, v8 row_ror:4 row_mask:0xf bank_mask:0xf
    s_nop 1
    v_add_f32_dpp v8, v8, v8 row_ror:8 row_mask:0xf bank_mask:0xf
    s_nop 1
    v_mov_b32 v9, v8
    s_nop 1
    v_permlane16_swap_b32 v9, v8
    s_nop 1
    v_add_f32 v8, v9, v8
    v_mov_b32 v9, v8
    s_nop 1
    v_permlane32_swap_b32 v9, v8
    s_nop 1
    v_add_f32 v8, v9, v8
    v_mul_f32 v8, 0x3ae38e39, v8
    v_sub_f32 v228, v228, v8
    v_sub_f32 v229, v229, v8
    v_sub_f32 v230, v230, v8
    v_sub_f32 v231, v231, v8
    v_sub_f32 v232, v232, v8
    v_sub_f32 v233, v233, v8
    v_sub_f32 v234, v234, v8
    v_sub_f32 v235, v235, v8
    v_sub_f32 v236, v236, v8
    v_sub_f32 v237, v237, v8
    v_sub_f32 v238, v238, v8
    v_sub_f32 v239, v239, v8
    v_sub_f32 v240, v240, v8
    v_sub_f32 v241, v241, v8
    v_sub_f32 v242, v242, v8
    v_sub_f32 v243, v243, v8
    v_mul_f32 v10, v228, v228
    v_mul_f32 v11, v236, v236
    v_fmac_f32 v10, v229, v229
    v_fmac_f32 v11, v237, v237
    v_fmac_f32 v10, v230, v230
    v_fmac_f32 v11, v238, v238
    v_fmac_f32 v10, v231, v231
    v_fmac_f32 v11, v239, v239
    v_fmac_f32 v10, v232, v232
    v_fmac_f32 v11, v240, v240
    v_fmac_f32 v10, v233, v233
    v_fmac_f32 v11, v241, v241
    v_fmac_f32 v10, v234, v234
    v_fmac_f32 v11, v242, v242
    v_fmac_f32 v10, v235, v235
    v_fmac_f32 v11, v243, v243
    v_cmp_gt_u32 vcc, 8, v1
    s_nop 1
    v_cndmask_b32 v11, 0, v11, vcc
    v_add_f32 v10, v10, v11
    s_nop 1
    v_add_f32_dpp v10, v10, v10 row_ror:1 row_mask:0xf bank_mask:0xf
    s_nop 1
    v_add_f32_dpp v10, v10, v10 row_ror:2 row_mask:0xf bank_mask:0xf
    s_nop 1
    v_add_f32_dpp v10, v10, v10 row_ror:4 row_mask:0xf bank_mask:0xf
    s_nop 1
    v_add_f32_dpp v10, v10, v10 row_ror:8 row_mask:0xf bank_mask:0xf
    s_nop 1
    v_mov_b32 v9, v10
    s_nop 1
    v_permlane16_swap_b32 v9, v10
    s_nop 1
    v_add_f32 v10, v9, v10
    v_mov_b32 v9, v10
    s_nop 1
    v_permlane32_swap_b32 v9, v10
    s_nop 1
    v_add_f32 v10, v9, v10
    v_mul_f32 v10, 0x3ae38e39, v10
    v_cvt_pk_bf16_f32 v8, v8, v8
    v_and_b32 v8, 0xffff0000, v8
    v_cvt_pk_bf16_f32 v10, v10, v10
    v_and_b32 v10, 0xffff0000, v10
    v_add_f32 v10, 0x3727c5ac, v10
    v_cvt_pk_bf16_f32 v10, v10, v10
    v_and_b32 v10, 0xffff0000, v10
    v_sqrt_f32 v10, v10
    s_nop 0
    v_cvt_pk_bf16_f32 v10, v10, v10
    v_and_b32 v10, 0xffff0000, v10
    v_rcp_f32 v11, v10
    v_sub_f32 v16, v16, v8
    v_sub_f32 v17, v17, v8
    v_sub_f32 v18, v18, v8
    v_sub_f32 v19, v19, v8
    v_sub_f32 v20, v20, v8
    v_sub_f32 v21, v21, v8
    v_sub_f32 v22, v22, v8
    v_sub_f32 v23, v23, v8
    v_sub_f32 v24, v24, v8
    v_cvt_pk_bf16_f32 v16, v16, v16
    v_and_b32 v16, 0xffff0000, v16
    v_cvt_pk_bf16_f32 v17, v17, v17
    v_and_b32 v17, 0xffff0000, v17
    v_cvt_pk_bf16_f32 v18, v18, v18
    v_and_b32 v18, 0xffff0000, v18
    v_cvt_pk_bf16_f32 v19, v19, v19
    v_and_b32 v19, 0xffff0000, v19
    v_cvt_pk_bf16_f32 v20, v20, v20
    v_and_b32 v20, 0xffff0000, v20
    v_cvt_pk_bf16_f32 v21, v21, v21
    v_and_b32 v21, 0xffff0000, v21
    v_cvt_pk_bf16_f32 v22, v22, v22
    v_and_b32 v22, 0xffff0000, v22
    v_cvt_pk_bf16_f32 v23, v23, v23
    v_and_b32 v23, 0xffff0000, v23
    v_cvt_pk_bf16_f32 v24, v24, v24
    v_and_b32 v24, 0xffff0000, v24
    v_mul_f32 v228, v16, v11
    v_mul_f32 v229, v17, v11
    v_mul_f32 v230, v18, v11
    v_mul_f32 v231, v19, v11
    v_mul_f32 v232, v20, v11
    v_mul_f32 v233, v21, v11
    v_mul_f32 v234, v22, v11
    v_mul_f32 v235, v23, v11
    v_mul_f32 v236, v24, v11
    v_fma_f32 v16, -v228, v10, v16
    v_fma_f32 v17, -v229, v10, v17
    v_fma_f32 v18, -v230, v10, v18
    v_fma_f32 v19, -v231, v10, v19
    v_fma_f32 v20, -v232, v10, v20
    v_fma_f32 v21, -v233, v10, v21
    v_fma_f32 v22, -v234, v10, v22
    v_fma_f32 v23, -v235, v10, v23
    v_fma_f32 v24, -v236, v10, v24
    v_fma_f32 v16, v16, v11, v228
    v_fma_f32 v17, v17, v11, v229
    v_fma_f32 v18, v18, v11, v230
    v_fma_f32 v19, v19, v11, v231
    v_fma_f32 v20, v20, v11, v232
    v_fma_f32 v21, v21, v11, v233
    v_fma_f32 v22, v22, v11, v234
    v_fma_f32 v23, v23, v11, v235
    v_fma_f32 v24, v24, v11, v236
    v_cvt_pk_bf16_f32 v16, v16, v16
    v_and_b32 v16, 0xffff0000, v16
    v_cvt_pk_bf16_f32 v17, v17, v17
    v_and_b32 v17, 0xffff0000, v17
    v_cvt_pk_bf16_f32 v18, v18, v18
    v_and_b32 v18, 0xffff0000, v18
    v_cvt_pk_bf16_f32 v19, v19, v19
    v_and_b32 v19, 0xffff0000, v19
    v_cvt_pk_bf16_f32 v20, v20, v20
    v_and_b32 v20, 0xffff0000, v20
    v_cvt_pk_bf16_f32 v21, v21, v21
    v_and_b32 v21, 0xffff0000, v21
    v_cvt_pk_bf16_f32 v22, v22, v22
    v_and_b32 v22, 0xffff0000, v22
    v_cvt_pk_bf16_f32 v23, v23, v23
    v_and_b32 v23, 0xffff0000, v23
    v_cvt_pk_bf16_f32 v24, v24, v24
    v_and_b32 v24, 0xffff0000, v24
    v_lshrrev_b32 v12, 4, v1
    v_lshl_add_u32 v12, v3, 3, v12
    v_lshlrev_b32 v12, 2, v12
    s_cmp_eq_u32 s98, -1
    s_cbranch_scc1 L_hq_done
    s_waitcnt vmcnt(0)
    v_lshlrev_b32 v228, 16, v44
    v_and_b32 v229, 0xffff0000, v44
    v_lshlrev_b32 v230, 16, v45
    v_and_b32 v231, 0xffff0000, v45
    v_lshlrev_b32 v232, 16, v46
    v_and_b32 v233, 0xffff0000, v46
    v_lshlrev_b32 v234, 16, v47
    v_and_b32 v235, 0xffff0000, v47
    v_mul_f32 v236, v228, v16
    v_mul_f32 v237, v229, v16
    v_mul_f32 v238, v230, v16
    v_mul_f32 v239, v231, v16
    v_mul_f32 v240, v232, v16
    v_mul_f32 v241, v233, v16
    v_mul_f32 v242, v234, v16
    v_mul_f32 v243, v235, v16
    v_lshlrev_b32 v228, 16, v48
    v_and_b32 v229, 0xffff0000, v48
    v_lshlrev_b32 v230, 16, v49
    v_and_b32 v231, 0xffff0000, v49
    v_lshlrev_b32 v232, 16, v50
    v_and_b32 v233, 0xffff0000, v50
    v_lshlrev_b32 v234, 16, v51
    v_and_b32 v235, 0xffff0000, v51
    v_fmac_f32 v236, v228, v17
    v_fmac_f32 v237, v229, v17
    v_fmac_f32 v238, v230, v17
    v_fmac_f32 v239, v231, v17
    v_fmac_f32 v240, v232, v17
    v_fmac_f32 v241, v233, v17
    v_fmac_f32 v242, v234, v17
    v_fmac_f32 v243, v235, v17
    v_lshlrev_b32 v228, 16, v52
    v_and_b32 v229, 0xffff0000, v52
    v_lshlrev_b32 v230, 16, v53
    v_and_b32 v231, 0xffff0000, v53
    v_lshlrev_b32 v232, 16, v54
    v_and_b32 v233, 0xffff0000, v54
    v_lshlrev_b32 v234, 16, v55
    v_and_b32 v235, 0xffff0000, v55
    v_fmac_f32 v236, v228, v18
    v_fmac_f32 v237, v229, v18
    v_fmac_f32 v238, v230, v18
    v_fmac_f32 v239, v231, v18
    v_fmac_f32 v240, v232, v18
    v_fmac_f32 v241, v233, v18
    v_fmac_f32 v242, v234, v18
    v_fmac_f32 v243, v235, v18
    v_lshlrev_b32 v228, 16, v56
    v_and_b32 v229, 0xffff0000, v56
    v_lshlrev_b32 v230, 16, v57
    v_and_b32 v231, 0xffff0000, v57
    v_lshlrev_b32 v232, 16, v58
    v_and_b32 v233, 0xffff0000, v58
    v_lshlrev_b32 v234, 16, v59
    v_and_b32 v235, 0xffff0000, v59
    v_fmac_f32 v236, v228, v19
    v_fmac_f32 v237, v229, v19
    v_fmac_f32 v238, v230, v19
    v_fmac_f32 v239, v231, v19
    v_fmac_f32 v240, v232, v19
    v_fmac_f32 v241, v233, v19
    v_fmac_f32 v242, v234, v19
    v_fmac_f32 v243, v235, v19
    v_lshlrev_b32 v228, 16, v60
    v_and_b32 v229, 0xffff0000, v60
    v_lshlrev_b32 v230, 16, v61
    v_and_b32 v231, 0xffff0000, v61
    v_lshlrev_b32 v232, 16, v62
    v_and_b32 v233, 0xffff0000, v62
    v_lshlrev_b32 v234, 16, v63
    v_and_b32 v235, 0xffff0000, v63
    v_fmac_f32 v236, v228, v20
    v_fmac_f32 v237, v229, v20
    v_fmac_f32 v238, v230, v20
    v_fmac_f32 v239, v231, v20
    v_fmac_f32 v240, v232, v20
    v_fmac_f32 v241, v233, v20
    v_fmac_f32 v242, v234, v20
    v_fmac_f32 v243, v235, v20
    v_lshlrev_b32 v228, 16, v64
    v_and_b32 v229, 0xffff0000, v64
    v_lshlrev_b32 v230, 16, v65
    v_and_b32 v231, 0xffff0000, v65
    v_lshlrev_b32 v232, 16, v66
    v_and_b32 v233, 0xffff0000, v66
    v_lshlrev_b32 v234, 16, v67
    v_and_b32 v235, 0xffff0000, v67
    v_fmac_f32 v236, v228, v21
    v_fmac_f32 v237, v229, v21
    v_fmac_f32 v238, v230, v21
    v_fmac_f32 v239, v231, v21
    v_fmac_f32 v240, v232, v21
    v_fmac_f32 v241, v233, v21
    v_fmac_f32 v242, v234, v21
    v_fmac_f32 v243, v235, v21
    v_lshlrev_b32 v228, 16, v68
    v_and_b32 v229, 0xffff0000, v68
    v_lshlrev_b32 v230, 16, v69
    v_and_b32 v231, 0xffff0000, v69
    v_lshlrev_b32 v232, 16, v70
    v_and_b32 v233, 0xffff0000, v70
    v_lshlrev_b32 v234, 16, v71
    v_and_b32 v235, 0xffff0000, v71
    v_fmac_f32 v236, v228, v22
    v_fmac_f32 v237, v229, v22
    v_fmac_f32 v238, v230, v22
    v_fmac_f32 v239, v231, v22
    v_fmac_f32 v240, v232, v22
    v_fmac_f32 v241, v233, v22
    v_fmac_f32 v242, v234, v22
    v_fmac_f32 v243, v235, v22
    v_lshlrev_b32 v228, 16, v72
    v_and_b32 v229, 0xffff0000, v72
    v_lshlrev_b32 v230, 16, v73
    v_and_b32 v231, 0xffff0000, v73
    v_lshlrev_b32 v232, 16, v74
    v_and_b32 v233, 0xffff0000, v74
    v_lshlrev_b32 v234, 16, v75
    v_and_b32 v235, 0xffff0000, v75
    v_fmac_f32 v236, v228, v23
    v_fmac_f32 v237, v229, v23
    v_fmac_f32 v238, v230, v23
    v_fmac_f32 v239, v231, v23
    v_fmac_f32 v240, v232, v23
    v_fmac_f32 v241, v233, v23
    v_fmac_f32 v242, v234, v23
    v_fmac_f32 v243, v235, v23
    v_lshlrev_b32 v228, 16, v76
    v_and_b32 v229, 0xffff0000, v76
    v_lshlrev_b32 v230, 16, v77
    v_and_b32 v231, 0xffff0000, v77
    v_lshlrev_b32 v232, 16, v78
    v_and_b32 v233, 0xffff0000, v78
    v_lshlrev_b32 v234, 16, v79
    v_and_b32 v235, 0xffff0000, v79
    v_fmac_f32 v236, v228, v24
    v_fmac_f32 v237, v229, v24
    v_fmac_f32 v238, v230, v24
    v_fmac_f32 v239, v231, v24
    v_fmac_f32 v240, v232, v24
    v_fmac_f32 v241, v233, v24
    v_fmac_f32 v242, v234, v24
    v_fmac_f32 v243, v235, v24
    v_add_f32_dpp v236, v236, v236 row_ror:4 row_mask:0xf bank_mask:0xf
    v_add_f32_dpp v237, v237, v237 row_ror:4 row_mask:0xf bank_mask:0xf
    v_add_f32_dpp v238, v238, v238 row_ror:4 row_mask:0xf bank_mask:0xf
    v_add_f32_dpp v239, v239, v239 row_ror:4 row_mask:0xf bank_mask:0xf
    v_add_f32_dpp v240, v240, v240 row_ror:4 row_mask:0xf bank_mask:0xf
    v_add_f32_dpp v241, v241, v241 row_ror:4 row_mask:0xf bank_mask:0xf
    v_add_f32_dpp v242, v242, v242 row_ror:4 row_mask:0xf bank_mask:0xf
    v_add_f32_dpp v243, v243, v243 row_ror:4 row_mask:0xf bank_mask:0xf
    v_add_f32_dpp v236, v236, v236 row_ror:8 row_mask:0xf bank_mask:0xf
    v_add_f32_dpp v237, v237, v237 row_ror:8 row_mask:0xf bank_mask:0xf
    v_add_f32_dpp v238, v238, v238 row_ror:8 row_mask:0xf bank_mask:0xf
    v_add_f32_dpp v239, v239, v239 row_ror:8 row_mask:0xf bank_mask:0xf
    v_add_f32_dpp v240, v240, v240 row_ror:8 row_mask:0xf bank_mask:0xf
    v_add_f32_dpp v241, v241, v241 row_ror:8 row_mask:0xf bank_mask:0xf
    v_add_f32_dpp v242, v242, v242 row_ror:8 row_mask:0xf bank_mask:0xf
    v_add_f32_dpp v243, v243, v243 row_ror:8 row_mask:0xf bank_mask:0xf
    v_permlane16_swap_b32 v236, v237
    v_permlane16_swap_b32 v238, v239
    v_permlane16_swap_b32 v240, v241
    v_permlane16_swap_b32 v242, v243
    v_add_f32 v236, v236, v237
    v_add_f32 v238, v238, v239
    v_add_f32 v240, v240, v241
    v_add_f32 v242, v242, v243
    s_mul_i32 s61, s3, 128
    v_add_u32 v13, s61, v12
    v_permlane32_swap_b32 v236, v238
    v_permlane32_swap_b32 v240, v242
    s_nop 0
    v_add_f32 v236, v236, v238
    v_add_f32 v240, v240, v242
    ds_write_b32 v13, v236 offset:0
    ds_write_b32 v13, v240 offset:16
    v_mov_b32 v13, 1536
    v_mov_b32 v14, 1
    s_waitcnt lgkmcnt(0)
    s_mov_b64 exec, 1
    ds_add_rtn_u32 v15, v13, v14
    s_waitcnt lgkmcnt(0)
    v_readfirstlane_b32 s61, v15
    s_mov_b64 exec, -1
    s_cmp_lg_u32 s61, 3
    s_cbranch_scc1 L_hq_done
    v_and_b32 v13, 31, v1
    v_lshlrev_b32 v13, 2, v13
    ds_read2_b32 v[8:9], v13 offset0:0 offset1:32
    ds_read2_b32 v[10:11], v13 offset0:64 offset1:96
    s_mul_i32 s65, s28, 9
    s_add_u32 s65, s65, s98
    s_lshl_b32 s65, s65, 7
    s_waitcnt lgkmcnt(0)
    v_add_f32 v8, v8, v9
    v_add_f32 v10, v10, v11
    v_add_f32 v8, v8, v10
    v_cvt_pk_bf16_f32 v8, v8, v8
    v_and_b32 v8, 0xffff0000, v8
    v_or_b32 v8, s96, v8
    s_mov_b32 exec_lo, 0xffffffff
    s_mov_b32 exec_hi, 0x0
    buffer_store_dword v8, v13, s[52:55], s65 offen offset:0 sc1
    s_mov_b64 exec, -1
L_hq_done:
    s_cmp_gt_u32 s29, 8
    s_cbranch_scc1 L_h_nogu
    s_mul_i32 s62, s28, 576
    s_lshl_b32 s63, s29, 6
    s_add_u32 s62, s62, s63
    buffer_load_dwordx4 v[44:47], v224, s[20:23], s62 offen
    buffer_load_dwordx4 v[80:83], v224, s[56:59], s62 offen
    s_add_u32 s62, s62, 147456
    buffer_load_dwordx4 v[48:51], v224, s[20:23], s62 offen
    buffer_load_dwordx4 v[84:87], v224, s[56:59], s62 offen
    s_add_u32 s62, s62, 147456
    buffer_load_dwordx4 v[52:55], v224, s[20:23], s62 offen
    buffer_load_dwordx4 v[88:91], v224, s[56:59], s62 offen
    s_add_u32 s62, s62, 147456
    buffer_load_dwordx4 v[56:59], v224, s[20:23], s62 offen
    buffer_load_dwordx4 v[92:95], v224, s[56:59], s62 offen
    s_add_u32 s62, s62, 147456
    buffer_load_dwordx4 v[60:63], v224, s[20:23], s62 offen
    buffer_load_dwordx4 v[96:99], v224, s[56:59], s62 offen
    s_add_u32 s62, s62, 147456
    buffer_load_dwordx4 v[64:67], v224, s[20:23], s62 offen
    buffer_load_dwordx4 v[100:103], v224, s[56:59], s62 offen
    s_add_u32 s62, s62, 147456
    buffer_load_dwordx4 v[68:71], v224, s[20:23], s62 offen
    buffer_load_dwordx4 v[104:107], v224, s[56:59], s62 offen
    s_add_u32 s62, s62, 147456
    buffer_load_dwordx4 v[72:75], v224, s[20:23], s62 offen
    buffer_load_dwordx4 v[108:111], v224, s[56:59], s62 offen
    s_add_u32 s62, s62, 147456
    buffer_load_dwordx4 v[76:79], v224, s[20:23], s62 offen
    buffer_load_dwordx4 v[112:115], v224, s[56:59], s62 offen
L_h_nogu:
    s_cmp_eq_u32 s99, -1
    s_cbranch_scc1 L_h_nowo
    s_lshl_b32 s63, s28, 2
    s_add_u32 s63, s63, s3
    s_lshl_b32 s61, s99, 7
    s_mul_i32 s62, s63, 73728
    s_add_u32 s62, s62, s61
    s_mul_i32 s63, s63, 82944
    s_add_u32 s63, s63, s61
    v_and_b32 v225, 7, v1
    v_and_b32 v226, 8, v1
    v_lshrrev_b32 v227, 4, v1
    v_lshl_add_u32 v226, v226, 2, v227
    v_mul_u32_u24 v226, 1152, v226
    v_lshl_add_u32 v226, v225, 4, v226
    v_lshrrev_b32 v227, 3, v1
    v_mul_u32_u24 v227, 10368, v227
    v_lshl_add_u32 v227, v225, 4, v227
    buffer_load_dwordx4 v[148:151], v227, s[44:47], s63 offen offset:0
    buffer_load_dwordx4 v[152:155], v227, s[44:47], s63 offen offset:1152
    buffer_load_dwordx4 v[156:159], v227, s[44:47], s63 offen offset:2304
    s_add_u32 s63, s63, 3456
    buffer_load_dwordx4 v[160:163], v227, s[44:47], s63 offen offset:0
    buffer_load_dwordx4 v[164:167], v227, s[44:47], s63 offen offset:1152
    buffer_load_dwordx4 v[168:171], v227, s[44:47], s63 offen offset:2304
    s_add_u32 s63, s63, 3456
    buffer_load_dwordx4 v[172:175], v227, s[44:47], s63 offen offset:0
    buffer_load_dwordx4 v[176:179], v227, s[44:47], s63 offen offset:1152
    buffer_load_dwordx4 v[180:183], v227, s[44:47], s63 offen offset:2304
L_h_nowo:
    s_mul_i32 s61, s28, 1152
    s_add_u32 s100, s26, s61
    s_addc_u32 s101, s27, 0
    s_lshl_b32 s62, s3, 8
    s_add_u32 s62, s62, 0
    s_add_u32 s100, s100, s62
    s_addc_u32 s101, s101, 0
    s_sub_u32 s62, 1024, s62
    s_mov_b32 s60, 2000000
    s_lshl_b32 s61, s3, 7
    v_lshl_add_u32 v10, v1, 1, s61
    s_branch L_c_poll
L_c_pre:
    s_sleep 1
    s_load_dword s4, s[100:101], 0 glc
    s_load_dword s5, s[100:101], 128 glc
    s_sub_u32 s60, s60, 1
    s_cbranch_scc1 L_c_poll
    s_waitcnt lgkmcnt(0)
    s_xor_b32 s4, s4, s96
    s_xor_b32 s5, s5, s96
    s_or_b32 s4, s4, s5
    s_and_b32 s4, s4, 0xfff8
    s_cbranch_scc1 L_c_pre
L_c_poll:
    s_waitcnt lgkmcnt(0)
    s_load_dwordx16 s[4:19], s[100:101], 0 glc
    s_load_dwordx16 s[32:47], s[100:101], 64 glc
    s_load_dwordx16 s[64:79], s[100:101], 128 glc
    s_load_dwordx16 s[80:95], s[100:101], 192 glc
    s_load_dwordx4 s[20:23], s[100:101], s62 glc
    s_sub_u32 s60, s60, 1
    s_waitcnt lgkmcnt(0)
    v_writelane_b32 v8, s4, 0
    v_writelane_b32 v8, s5, 1
    v_writelane_b32 v8, s6, 2
    v_writelane_b32 v8, s7, 3
    v_writelane_b32 v8, s8, 4
    v_writelane_b32 v8, s9, 5
    v_writelane_b32 v8, s10, 6
    v_writelane_b32 v8, s11, 7
    v_writelane_b32 v8, s12, 8
    v_writelane_b32 v8, s13, 9
    v_writelane_b32 v8, s14, 10
    v_writelane_b32 v8, s15, 11
    v_writelane_b32 v8, s16, 12
    v_writelane_b32 v8, s17, 13
    v_writelane_b32 v8, s18, 14
    v_writelane_b32 v8, s19, 15
    v_writelane_b32 v8, s32, 16
    v_writelane_b32 v8, s33, 17
    v_writelane_b32 v8, s34, 18
    v_writelane_b32 v8, s35, 19
    v_writelane_b32 v8, s36, 20
    v_writelane_b32 v8, s37, 21
    v_writelane_b32 v8, s38, 22
    v_writelane_b32 v8, s39, 23
    v_writelane_b32 v8, s40, 24
    v_writelane_b32 v8, s41, 25
    v_writelane_b32 v8, s42, 26
    v_writelane_b32 v8, s43, 27
    v_writelane_b32 v8, s44, 28
    v_writelane_b32 v8, s45, 29
    v_writelane_b32 v8, s46, 30
    v_writelane_b32 v8, s47, 31
    v_writelane_b32 v8, s64, 32
    v_writelane_b32 v8, s65, 33
    v_writelane_b32 v8, s66, 34
    v_writelane_b32 v8, s67, 35
    v_writelane_b32 v8, s68, 36
    v_writelane_b32 v8, s69, 37
    v_writelane_b32 v8, s70, 38
    v_writelane_b32 v8, s71, 39
    v_writelane_b32 v8, s72, 40
    v_writelane_b32 v8, s73, 41
    v_writelane_b32 v8, s74, 42
    v_writelane_b32 v8, s75, 43
    v_writelane_b32 v8, s76, 44
    v_writelane_b32 v8, s77, 45
    v_writelane_b32 v8, s78, 46
    v_writelane_b32 v8, s79, 47
    v_writelane_b32 v8, s80, 48
    v_writelane_b32 v8, s81, 49
    v_writelane_b32 v8, s82, 50
    v_writelane_b32 v8, s83, 51
    v_writelane_b32 v8, s84, 52
    v_writelane_b32 v8, s85, 53
    v_writelane_b32 v8, s86, 54
    v_writelane_b32 v8, s87, 55
    v_writelane_b32 v8, s88, 56
    v_writelane_b32 v8, s89, 57
    v_writelane_b32 v8, s90, 58
    v_writelane_b32 v8, s91, 59
    v_writelane_b32 v8, s92, 60
    v_writelane_b32 v8, s93, 61
    v_writelane_b32 v8, s94, 62
    v_writelane_b32 v8, s95, 63
    s_xor_b32 s20, s20, s96
    s_xor_b32 s21, s21, s96
    s_xor_b32 s22, s22, s96
    s_xor_b32 s23, s23, s96
    s_or_b32 s20, s20, s21
    s_or_b32 s22, s22, s23
    s_or_b32 s20, s20, s22
    v_xor_b32 v9, s96, v8
    v_or_b32 v9, s20, v9
    v_and_b32 v14, 0xfff8, v9
    v_cmp_ne_u32 vcc, 0, v14
    s_cmp_gt_i32 s60, 0
    s_cselect_b64 s[4:5], vcc, 0
    s_cmp_lg_u64 s[4:5], 0
    s_cbranch_scc1 L_c_pre
    v_and_b32 v11, 7, v9
    v_mov_b32 v13, 1544
    v_mov_b32 v14, 1
    v_mov_b32 v9, s97
    ds_write_b16_d16_hi v10, v8 offset:1792
    ds_write_b32 v13, v9 offset:12
    ds_or_b32 v13, v11 offset:8
    s_waitcnt lgkmcnt(0)
    s_mov_b64 exec, 1
    ds_add_u32 v13, v14
    s_mov_b64 exec, -1
    s_setprio 0
    v_and_b32 v8, 7, v1
    v_lshrrev_b32 v9, 1, v8
    v_and_b32 v8, 1, v8
    v_mov_b32 v10, 0xffff
    v_lshlrev_b32 v8, 4, v8
    v_lshlrev_b32 v8, v8, v10
    v_cmp_eq_u32 vcc, 0, v9
    s_nop 1
    v_cndmask_b32 v188, 0, v8, vcc
    v_cmp_eq_u32 vcc, 1, v9
    s_nop 1
    v_cndmask_b32 v189, 0, v8, vcc
    v_cmp_eq_u32 vcc, 2, v9
    s_nop 1
    v_cndmask_b32 v190, 0, v8, vcc
    v_cmp_eq_u32 vcc, 3, v9
    s_nop 1
    v_cndmask_b32 v191, 0, v8, vcc
    v_mov_b32 v226, s97
    s_waitcnt vmcnt(0)
    s_cmp_gt_u32 s29, 8
    s_cbranch_scc1 L_hg_done
    v_lshlrev_b32 v228, 16, v44
    v_and_b32 v229, 0xffff0000, v44
    v_lshlrev_b32 v230, 16, v45
    v_and_b32 v231, 0xffff0000, v45
    v_lshlrev_b32 v232, 16, v46
    v_and_b32 v233, 0xffff0000, v46
    v_lshlrev_b32 v234, 16, v47
    v_and_b32 v235, 0xffff0000, v47
    v_mul_f32 v236, v228, v16
    v_mul_f32 v237, v229, v16
    v_mul_f32 v238, v230, v16
    v_mul_f32 v239, v231, v16
    v_mul_f32 v240, v232, v16
    v_mul_f32 v241, v233, v16
    v_mul_f32 v242, v234, v16
    v_mul_f32 v243, v235, v16
    v_lshlrev_b32 v228, 16, v48
    v_and_b32 v229, 0xffff0000, v48
    v_lshlrev_b32 v230, 16, v49
    v_and_b32 v231, 0xffff0000, v49
    v_lshlrev_b32 v232, 16, v50
    v_and_b32 v233, 0xffff0000, v50
    v_lshlrev_b32 v234, 16, v51
    v_and_b32 v235, 0xffff0000, v51
    v_fmac_f32 v236, v228, v17
    v_fmac_f32 v237, v229, v17
    v_fmac_f32 v238, v230, v17
    v_fmac_f32 v239, v231, v17
    v_fmac_f32 v240, v232, v17
    v_fmac_f32 v241, v233, v17
    v_fmac_f32 v242, v234, v17
    v_fmac_f32 v243, v235, v17
    v_lshlrev_b32 v228, 16, v52
    v_and_b32 v229, 0xffff0000, v52
    v_lshlrev_b32 v230, 16, v53
    v_and_b32 v231, 0xffff0000, v53
    v_lshlrev_b32 v232, 16, v54
    v_and_b32 v233, 0xffff0000, v54
    v_lshlrev_b32 v234, 16, v55
    v_and_b32 v235, 0xffff0000, v55
    v_fmac_f32 v236, v228, v18
    v_fmac_f32 v237, v229, v18
    v_fmac_f32 v238, v230, v18
    v_fmac_f32 v239, v231, v18
    v_fmac_f32 v240, v232, v18
    v_fmac_f32 v241, v233, v18
    v_fmac_f32 v242, v234, v18
    v_fmac_f32 v243, v235, v18
    v_lshlrev_b32 v228, 16, v56
    v_and_b32 v229, 0xffff0000, v56
    v_lshlrev_b32 v230, 16, v57
    v_and_b32 v231, 0xffff0000, v57
    v_lshlrev_b32 v232, 16, v58
    v_and_b32 v233, 0xffff0000, v58
    v_lshlrev_b32 v234, 16, v59
    v_and_b32 v235, 0xffff0000, v59
    v_fmac_f32 v236, v228, v19
    v_fmac_f32 v237, v229, v19
    v_fmac_f32 v238, v230, v19
    v_fmac_f32 v239, v231, v19
    v_fmac_f32 v240, v232, v19
    v_fmac_f32 v241, v233, v19
    v_fmac_f32 v242, v234, v19
    v_fmac_f32 v243, v235, v19
    v_lshlrev_b32 v228, 16, v60
    v_and_b32 v229, 0xffff0000, v60
    v_lshlrev_b32 v230, 16, v61
    v_and_b32 v231, 0xffff0000, v61
    v_lshlrev_b32 v232, 16, v62
    v_and_b32 v233, 0xffff0000, v62
    v_lshlrev_b32 v234, 16, v63
    v_and_b32 v235, 0xffff0000, v63
    v_fmac_f32 v236, v228, v20
    v_fmac_f32 v237, v229, v20
    v_fmac_f32 v238, v230, v20
    v_fmac_f32 v239, v231, v20
    v_fmac_f32 v240, v232, v20
    v_fmac_f32 v241, v233, v20
    v_fmac_f32 v242, v234, v20
    v_fmac_f32 v243, v235, v20
    v_lshlrev_b32 v228, 16, v64
    v_and_b32 v229, 0xffff0000, v64
    v_lshlrev_b32 v230, 16, v65
    v_and_b32 v231, 0xffff0000, v65
    v_lshlrev_b32 v232, 16, v66
    v_and_b32 v233, 0xffff0000, v66
    v_lshlrev_b32 v234, 16, v67
    v_and_b32 v235, 0xffff0000, v67
    v_fmac_f32 v236, v228, v21
    v_fmac_f32 v237, v229, v21
    v_fmac_f32 v238, v230, v21
    v_fmac_f32 v239, v231, v21
    v_fmac_f32 v240, v232, v21
    v_fmac_f32 v241, v233, v21
    v_fmac_f32 v242, v234, v21
    v_fmac_f32 v243, v235, v21
    v_lshlrev_b32 v228, 16, v68
    v_and_b32 v229, 0xffff0000, v68
    v_lshlrev_b32 v230, 16, v69
    v_and_b32 v231, 0xffff0000, v69
    v_lshlrev_b32 v232, 16, v70
    v_and_b32 v233, 0xffff0000, v70
    v_lshlrev_b32 v234, 16, v71
    v_and_b32 v235, 0xffff0000, v71
    v_fmac_f32 v236, v228, v22
    v_fmac_f32 v237, v229, v22
    v_fmac_f32 v238, v230, v22
    v_fmac_f32 v239, v231, v22
    v_fmac_f32 v240, v232, v22
    v_fmac_f32 v241, v233, v22
    v_fmac_f32 v242, v234, v22
    v_fmac_f32 v243, v235, v22
    v_lshlrev_b32 v228, 16, v72
    v_and_b32 v229, 0xffff0000, v72
    v_lshlrev_b32 v230, 16, v73
    v_and_b32 v231, 0xffff0000, v73
    v_lshlrev_b32 v232, 16, v74
    v_and_b32 v233, 0xffff0000, v74
    v_lshlrev_b32 v234, 16, v75
    v_and_b32 v235, 0xffff0000, v75
    v_fmac_f32 v236, v228, v23
    v_fmac_f32 v237, v229, v23
    v_fmac_f32 v238, v230, v23
    v_fmac_f32 v239, v231, v23
    v_fmac_f32 v240, v232, v23
    v_fmac_f32 v241, v233, v23
    v_fmac_f32 v242, v234, v23
    v_fmac_f32 v243, v235, v23
    v_lshlrev_b32 v228, 16, v76
    v_and_b32 v229, 0xffff0000, v76
    v_lshlrev_b32 v230, 16, v77
    v_and_b32 v231, 0xffff0000, v77
    v_lshlrev_b32 v232, 16, v78
    v_and_b32 v233, 0xffff0000, v78
    v_lshlrev_b32 v234, 16, v79
    v_and_b32 v235, 0xffff0000, v79
    v_fmac_f32 v236, v228, v24
    v_fmac_f32 v237, v229, v24
    v_fmac_f32 v238, v230, v24
    v_fmac_f32 v239, v231, v24
    v_fmac_f32 v240, v232, v24
    v_fmac_f32 v241, v233, v24
    v_fmac_f32 v242, v234, v24
    v_fmac_f32 v243, v235, v24
    v_add_f32_dpp v236, v236, v236 row_ror:4 row_mask:0xf bank_mask:0xf
    v_add_f32_dpp v237, v237, v237 row_ror:4 row_mask:0xf bank_mask:0xf
    v_add_f32_dpp v238, v238, v238 row_ror:4 row_mask:0xf bank_mask:0xf
    v_add_f32_dpp v239, v239, v239 row_ror:4 row_mask:0xf bank_mask:0xf
    v_add_f32_dpp v240, v240, v240 row_ror:4 row_mask:0xf bank_mask:0xf
    v_add_f32_dpp v241, v241, v241 row_ror:4 row_mask:0xf bank_mask:0xf
    v_add_f32_dpp v242, v242, v242 row_ror:4 row_mask:0xf bank_mask:0xf
    v_add_f32_dpp v243, v243, v243 row_ror:4 row_mask:0xf bank_mask:0xf
    v_add_f32_dpp v236, v236, v236 row_ror:8 row_mask:0xf bank_mask:0xf
    v_add_f32_dpp v237, v237, v237 row_ror:8 row_mask:0xf bank_mask:0xf
    v_add_f32_dpp v238, v238, v238 row_ror:8 row_mask:0xf bank_mask:0xf
    v_add_f32_dpp v239, v239, v239 row_ror:8 row_mask:0xf bank_mask:0xf
    v_add_f32_dpp v240, v240, v240 row_ror:8 row_mask:0xf bank_mask:0xf
    v_add_f32_dpp v241, v241, v241 row_ror:8 row_mask:0xf bank_mask:0xf
    v_add_f32_dpp v242, v242, v242 row_ror:8 row_mask:0xf bank_mask:0xf
    v_add_f32_dpp v243, v243, v243 row_ror:8 row_mask:0xf bank_mask:0xf
    v_permlane16_swap_b32 v236, v237
    v_permlane16_swap_b32 v238, v239
    v_permlane16_swap_b32 v240, v241
    v_permlane16_swap_b32 v242, v243
    v_add_f32 v236, v236, v237
    v_add_f32 v238, v238, v239
    v_add_f32 v240, v240, v241
    v_add_f32 v242, v242, v243
    s_mul_i32 s61, s3, 256
    v_add_u32 v13, s61, v12
    v_permlane32_swap_b32 v236, v238
    v_permlane32_swap_b32 v240, v242
    s_nop 0
    v_add_f32 v236, v236, v238
    v_add_f32 v240, v240, v242
    ds_write_b32 v13, v236 offset:512
    ds_write_b32 v13, v240 offset:528
    v_lshlrev_b32 v228, 16, v80
    v_and_b32 v229, 0xffff0000, v80
    v_lshlrev_b32 v230, 16, v81
    v_and_b32 v231, 0xffff0000, v81
    v_lshlrev_b32 v232, 16, v82
    v_and_b32 v233, 0xffff0000, v82
    v_lshlrev_b32 v234, 16, v83
    v_and_b32 v235, 0xffff0000, v83
    v_mul_f32 v236, v228, v16
    v_mul_f32 v237, v229, v16
    v_mul_f32 v238, v230, v16
    v_mul_f32 v239, v231, v16
    v_mul_f32 v240, v232, v16
    v_mul_f32 v241, v233, v16
    v_mul_f32 v242, v234, v16
    v_mul_f32 v243, v235, v16
    v_lshlrev_b32 v228, 16, v84
    v_and_b32 v229, 0xffff0000, v84
    v_lshlrev_b32 v230, 16, v85
    v_and_b32 v231, 0xffff0000, v85
    v_lshlrev_b32 v232, 16, v86
    v_and_b32 v233, 0xffff0000, v86
    v_lshlrev_b32 v234, 16, v87
    v_and_b32 v235, 0xffff0000, v87
    v_fmac_f32 v236, v228, v17
    v_fmac_f32 v237, v229, v17
    v_fmac_f32 v238, v230, v17
    v_fmac_f32 v239, v231, v17
    v_fmac_f32 v240, v232, v17
    v_fmac_f32 v241, v233, v17
    v_fmac_f32 v242, v234, v17
    v_fmac_f32 v243, v235, v17
    v_lshlrev_b32 v228, 16, v88
    v_and_b32 v229, 0xffff0000, v88
    v_lshlrev_b32 v230, 16, v89
    v_and_b32 v231, 0xffff0000, v89
    v_lshlrev_b32 v232, 16, v90
    v_and_b32 v233, 0xffff0000, v90
    v_lshlrev_b32 v234, 16, v91
    v_and_b32 v235, 0xffff0000, v91
    v_fmac_f32 v236, v228, v18
    v_fmac_f32 v237, v229, v18
    v_fmac_f32 v238, v230, v18
    v_fmac_f32 v239, v231, v18
    v_fmac_f32 v240, v232, v18
    v_fmac_f32 v241, v233, v18
    v_fmac_f32 v242, v234, v18
    v_fmac_f32 v243, v235, v18
    v_lshlrev_b32 v228, 16, v92
    v_and_b32 v229, 0xffff0000, v92
    v_lshlrev_b32 v230, 16, v93
    v_and_b32 v231, 0xffff0000, v93
    v_lshlrev_b32 v232, 16, v94
    v_and_b32 v233, 0xffff0000, v94
    v_lshlrev_b32 v234, 16, v95
    v_and_b32 v235, 0xffff0000, v95
    v_fmac_f32 v236, v228, v19
    v_fmac_f32 v237, v229, v19
    v_fmac_f32 v238, v230, v19
    v_fmac_f32 v239, v231, v19
    v_fmac_f32 v240, v232, v19
    v_fmac_f32 v241, v233, v19
    v_fmac_f32 v242, v234, v19
    v_fmac_f32 v243, v235, v19
    v_lshlrev_b32 v228, 16, v96
    v_and_b32 v229, 0xffff0000, v96
    v_lshlrev_b32 v230, 16, v97
    v_and_b32 v231, 0xffff0000, v97
    v_lshlrev_b32 v232, 16, v98
    v_and_b32 v233, 0xffff0000, v98
    v_lshlrev_b32 v234, 16, v99
    v_and_b32 v235, 0xffff0000, v99
    v_fmac_f32 v236, v228, v20
    v_fmac_f32 v237, v229, v20
    v_fmac_f32 v238, v230, v20
    v_fmac_f32 v239, v231, v20
    v_fmac_f32 v240, v232, v20
    v_fmac_f32 v241, v233, v20
    v_fmac_f32 v242, v234, v20
    v_fmac_f32 v243, v235, v20
    v_lshlrev_b32 v228, 16, v100
    v_and_b32 v229, 0xffff0000, v100
    v_lshlrev_b32 v230, 16, v101
    v_and_b32 v231, 0xffff0000, v101
    v_lshlrev_b32 v232, 16, v102
    v_and_b32 v233, 0xffff0000, v102
    v_lshlrev_b32 v234, 16, v103
    v_and_b32 v235, 0xffff0000, v103
    v_fmac_f32 v236, v228, v21
    v_fmac_f32 v237, v229, v21
    v_fmac_f32 v238, v230, v21
    v_fmac_f32 v239, v231, v21
    v_fmac_f32 v240, v232, v21
    v_fmac_f32 v241, v233, v21
    v_fmac_f32 v242, v234, v21
    v_fmac_f32 v243, v235, v21
    v_lshlrev_b32 v228, 16, v104
    v_and_b32 v229, 0xffff0000, v104
    v_lshlrev_b32 v230, 16, v105
    v_and_b32 v231, 0xffff0000, v105
    v_lshlrev_b32 v232, 16, v106
    v_and_b32 v233, 0xffff0000, v106
    v_lshlrev_b32 v234, 16, v107
    v_and_b32 v235, 0xffff0000, v107
    v_fmac_f32 v236, v228, v22
    v_fmac_f32 v237, v229, v22
    v_fmac_f32 v238, v230, v22
    v_fmac_f32 v239, v231, v22
    v_fmac_f32 v240, v232, v22
    v_fmac_f32 v241, v233, v22
    v_fmac_f32 v242, v234, v22
    v_fmac_f32 v243, v235, v22
    v_lshlrev_b32 v228, 16, v108
    v_and_b32 v229, 0xffff0000, v108
    v_lshlrev_b32 v230, 16, v109
    v_and_b32 v231, 0xffff0000, v109
    v_lshlrev_b32 v232, 16, v110
    v_and_b32 v233, 0xffff0000, v110
    v_lshlrev_b32 v234, 16, v111
    v_and_b32 v235, 0xffff0000, v111
    v_fmac_f32 v236, v228, v23
    v_fmac_f32 v237, v229, v23
    v_fmac_f32 v238, v230, v23
    v_fmac_f32 v239, v231, v23
    v_fmac_f32 v240, v232, v23
    v_fmac_f32 v241, v233, v23
    v_fmac_f32 v242, v234, v23
    v_fmac_f32 v243, v235, v23
    v_lshlrev_b32 v228, 16, v112
    v_and_b32 v229, 0xffff0000, v112
    v_lshlrev_b32 v230, 16, v113
    v_and_b32 v231, 0xffff0000, v113
    v_lshlrev_b32 v232, 16, v114
    v_and_b32 v233, 0xffff0000, v114
    v_lshlrev_b32 v234, 16, v115
    v_and_b32 v235, 0xffff0000, v115
    v_fmac_f32 v236, v228, v24
    v_fmac_f32 v237, v229, v24
    v_fmac_f32 v238, v230, v24
    v_fmac_f32 v239, v231, v24
    v_fmac_f32 v240, v232, v24
    v_fmac_f32 v241, v233, v24
    v_fmac_f32 v242, v234, v24
    v_fmac_f32 v243, v235, v24
    v_add_f32_dpp v236, v236, v236 row_ror:4 row_mask:0xf bank_mask:0xf
    v_add_f32_dpp v237, v237, v237 row_ror:4 row_mask:0xf bank_mask:0xf
    v_add_f32_dpp v238, v238, v238 row_ror:4 row_mask:0xf bank_mask:0xf
    v_add_f32_dpp v239, v239, v239 row_ror:4 row_mask:0xf bank_mask:0xf
    v_add_f32_dpp v240, v240, v240 row_ror:4 row_mask:0xf bank_mask:0xf
    v_add_f32_dpp v241, v241, v241 row_ror:4 row_mask:0xf bank_mask:0xf
    v_add_f32_dpp v242, v242, v242 row_ror:4 row_mask:0xf bank_mask:0xf
    v_add_f32_dpp v243, v243, v243 row_ror:4 row_mask:0xf bank_mask:0xf
    v_add_f32_dpp v236, v236, v236 row_ror:8 row_mask:0xf bank_mask:0xf
    v_add_f32_dpp v237, v237, v237 row_ror:8 row_mask:0xf bank_mask:0xf
    v_add_f32_dpp v238, v238, v238 row_ror:8 row_mask:0xf bank_mask:0xf
    v_add_f32_dpp v239, v239, v239 row_ror:8 row_mask:0xf bank_mask:0xf
    v_add_f32_dpp v240, v240, v240 row_ror:8 row_mask:0xf bank_mask:0xf
    v_add_f32_dpp v241, v241, v241 row_ror:8 row_mask:0xf bank_mask:0xf
    v_add_f32_dpp v242, v242, v242 row_ror:8 row_mask:0xf bank_mask:0xf
    v_add_f32_dpp v243, v243, v243 row_ror:8 row_mask:0xf bank_mask:0xf
    v_permlane16_swap_b32 v236, v237
    v_permlane16_swap_b32 v238, v239
    v_permlane16_swap_b32 v240, v241
    v_permlane16_swap_b32 v242, v243
    v_add_f32 v236, v236, v237
    v_add_f32 v238, v238, v239
    v_add_f32 v240, v240, v241
    v_add_f32 v242, v242, v243
    s_mul_i32 s61, s3, 256
    v_add_u32 v13, s61, v12
    v_permlane32_swap_b32 v236, v238
    v_permlane32_swap_b32 v240, v242
    s_nop 0
    v_add_f32 v236, v236, v238
    v_add_f32 v240, v240, v242
    ds_write_b32 v13, v236 offset:640
    ds_write_b32 v13, v240 offset:656
    v_mov_b32 v13, 1540
    v_mov_b32 v14, 1
    s_waitcnt lgkmcnt(0)
    s_mov_b64 exec, 1
    ds_add_rtn_u32 v15, v13, v14
    s_waitcnt lgkmcnt(0)
    v_readfirstlane_b32 s61, v15
    s_mov_b64 exec, -1
    s_cmp_lg_u32 s61, 3
    s_cbranch_scc1 L_hg_done
    v_and_b32 v13, 31, v1
    v_lshlrev_b32 v13, 2, v13
    v_mov_b32 v14, 1552
    ds_read_b32 v14, v14
    ds_read_b32 v228, v13 offset:512
    ds_read_b32 v229, v13 offset:640
    ds_read_b32 v230, v13 offset:768
    ds_read_b32 v231, v13 offset:896
    ds_read_b32 v232, v13 offset:1024
    ds_read_b32 v233, v13 offset:1152
    ds_read_b32 v234, v13 offset:1280
    ds_read_b32 v235, v13 offset:1408
    s_mul_i32 s64, s28, 1152
    s_lshl_b32 s65, s29, 7
    s_add_u32 s64, s64, s65
    s_add_u32 s64, s64, 36864
    s_waitcnt lgkmcnt(0)
    v_readfirstlane_b32 s65, v14
    v_add_f32 v8, v228, v230
    v_add_f32 v9, v229, v231
    v_add_f32 v10, v232, v234
    v_add_f32 v11, v233, v235
    v_add_f32 v8, v8, v10
    v_add_f32 v9, v9, v11
    v_cvt_pk_bf16_f32 v8, v8, v8
    v_and_b32 v8, 0xffff0000, v8
    v_cvt_pk_bf16_f32 v9, v9, v9
    v_and_b32 v9, 0xffff0000, v9
    v_mul_f32 v8, 0xbfb8aa3b, v8
    v_exp_f32 v8, v8
    s_nop 0
    v_add_f32 v8, 1.0, v8
    v_rcp_f32 v8, v8
    s_nop 0
    v_cvt_pk_bf16_f32 v8, v8, v8
    v_and_b32 v8, 0xffff0000, v8
    v_mul_f32 v8, v8, v9
    v_cvt_pk_bf16_f32 v8, v8, v8
    s_mov_b32 s60, 0xffff
    v_bfi_b32 v8, s60, v226, v8
    s_mov_b32 exec_lo, 0xffffffff
    s_mov_b32 exec_hi, 0x0
    s_cmp_eq_u32 s65, 0
    s_cbranch_scc1 L_h_plain
    buffer_store_dword v8, v13, s[52:55], s64 offen sc1
    s_branch L_h_stored
L_h_plain:
    buffer_store_dword v8, v13, s[52:55], s64 offen
L_h_stored:
    s_mov_b64 exec, -1
L_hg_done:
    s_cmp_eq_u32 s99, -1
    s_cbranch_scc1 L_hy_done
    s_mul_i32 s64, s28, 1152
    s_mul_i32 s65, s3, 288
    s_add_u32 s64, s64, s65
    s_add_u32 s64, s64, 36864
    v_lshrrev_b32 v4, 3, v1
    v_mul_u32_u24 v4, 36, v4
    s_mov_b32 s60, 2000000
L_y_poll:
    buffer_load_dwordx4 v[8:11], v4, s[52:55], s64 offen sc1
    buffer_load_dwordx4 v[12:15], v4, s[52:55], s64 offen offset:16 sc1
    buffer_load_dword v16, v4, s[52:55], s64 offen offset:32 sc1
    s_sub_u32 s60, s60, 1
    s_cbranch_scc1 L_y_ok
    s_waitcnt vmcnt(0)
    v_xor_b32 v18, s97, v8
    v_bitop3_b32 v18, v18, v9, s97 bitop3:0xf6
    v_bitop3_b32 v18, v18, v10, s97 bitop3:0xf6
    v_bitop3_b32 v18, v18, v11, s97 bitop3:0xf6
    v_bitop3_b32 v18, v18, v12, s97 bitop3:0xf6
    v_bitop3_b32 v18, v18, v13, s97 bitop3:0xf6
    v_bitop3_b32 v18, v18, v14, s97 bitop3:0xf6
    v_bitop3_b32 v18, v18, v15, s97 bitop3:0xf6
    v_bitop3_b32 v18, v18, v16, s97 bitop3:0xf6
    v_and_b32 v18, 0xffff, v18
    v_cmp_ne_u32 vcc, 0, v18
    s_cbranch_vccz L_y_ok
    s_sleep 32
    s_branch L_y_poll
L_y_ok:
    s_mov_b32 s60, 0x03020302
    s_waitcnt vmcnt(0)
    v_perm_b32 v8, v8, v8, s60
    v_perm_b32 v9, v9, v9, s60
    v_perm_b32 v10, v10, v10, s60
    v_perm_b32 v11, v11, v11, s60
    v_perm_b32 v12, v12, v12, s60
    v_perm_b32 v13, v13, v13, s60
    v_perm_b32 v14, v14, v14, s60
    v_perm_b32 v15, v15, v15, s60
    v_perm_b32 v16, v16, v16, s60
    v_and_b32 v28, v8, v188
    v_and_b32 v29, v8, v189
    v_and_b32 v30, v8, v190
    v_and_b32 v31, v8, v191
    s_nop 1
    v_mfma_f32_16x16x32_bf16 v[36:39], v[28:31], v[148:151], 0
    v_and_b32 v32, v9, v188
    v_and_b32 v33, v9, v189
    v_and_b32 v34, v9, v190
    v_and_b32 v35, v9, v191
    s_nop 1
    v_mfma_f32_16x16x32_bf16 v[36:39], v[32:35], v[152:155], v[36:39]
    v_and_b32 v28, v10, v188
    v_and_b32 v29, v10, v189
    v_and_b32 v30, v10, v190
    v_and_b32 v31, v10, v191
    s_nop 1
    v_mfma_f32_16x16x32_bf16 v[36:39], v[28:31], v[156:159], v[36:39]
    v_and_b32 v32, v11, v188
    v_and_b32 v33, v11, v189
    v_and_b32 v34, v11, v190
    v_and_b32 v35, v11, v191
    s_nop 1
    v_mfma_f32_16x16x32_bf16 v[36:39], v[32:35], v[160:163], v[36:39]
    v_and_b32 v28, v12, v188
    v_and_b32 v29, v12, v189
    v_and_b32 v30, v12, v190
    v_and_b32 v31, v12, v191
    s_nop 1
    v_mfma_f32_16x16x32_bf16 v[36:39], v[28:31], v[164:167], v[36:39]
    v_and_b32 v32, v13, v188
    v_and_b32 v33, v13, v189
    v_and_b32 v34, v13, v190
    v_and_b32 v35, v13, v191
    s_nop 1
    v_mfma_f32_16x16x32_bf16 v[36:39], v[32:35], v[168:171], v[36:39]
    v_and_b32 v28, v14, v188
    v_and_b32 v29, v14, v189
    v_and_b32 v30, v14, v190
    v_and_b32 v31, v14, v191
    s_nop 1
    v_mfma_f32_16x16x32_bf16 v[36:39], v[28:31], v[172:175], v[36:39]
    v_and_b32 v32, v15, v188
    v_and_b32 v33, v15, v189
    v_and_b32 v34, v15, v190
    v_and_b32 v35, v15, v191
    s_nop 1
    v_mfma_f32_16x16x32_bf16 v[36:39], v[32:35], v[176:179], v[36:39]
    v_and_b32 v28, v16, v188
    v_and_b32 v29, v16, v189
    v_and_b32 v30, v16, v190
    v_and_b32 v31, v16, v191
    s_nop 1
    v_mfma_f32_16x16x32_bf16 v[36:39], v[28:31], v[180:183], v[36:39]
    v_and_b32 v6, 7, v1
    v_and_b32 v7, 16, v1
    v_lshl_add_u32 v6, v6, 5, v7
    s_lshl_b32 s61, s3, 8
    v_add_u32 v7, s61, v6
    s_nop 3
    v_mov_b32 v28, v36
    v_mov_b32 v29, v37
    v_mov_b32 v30, v38
    v_mov_b32 v31, v39
    v_permlane32_swap_b32 v28, v36
    v_permlane32_swap_b32 v29, v37
    v_permlane32_swap_b32 v30, v38
    v_permlane32_swap_b32 v31, v39
    v_add_f32_dpp v28, v36, v28 row_ror:8 row_mask:0xf bank_mask:0xf
    v_add_f32_dpp v29, v37, v29 row_ror:8 row_mask:0xf bank_mask:0xf
    v_add_f32_dpp v30, v38, v30 row_ror:8 row_mask:0xf bank_mask:0xf
    v_add_f32_dpp v31, v39, v31 row_ror:8 row_mask:0xf bank_mask:0xf
    s_mov_b32 exec_lo, 0xff00ff
    s_mov_b32 exec_hi, 0x0
    ds_write_b128 v7, v[28:31] offset:6912
    s_mov_b64 exec, -1
    v_mov_b32 v13, 1560
    v_mov_b32 v14, 1
    s_waitcnt lgkmcnt(0)
    s_mov_b64 exec, 1
    ds_add_rtn_u32 v15, v13, v14
    s_waitcnt lgkmcnt(0)
    v_readfirstlane_b32 s61, v15
    s_mov_b64 exec, -1
    s_cmp_lg_u32 s61, 3
    s_cbranch_scc1 L_hy_done
    ds_read_b128 v[8:11], v6 offset:6912
    ds_read_b128 v[12:15], v6 offset:7168
    ds_read_b128 v[16:19], v6 offset:7424
    ds_read_b128 v[20:23], v6 offset:7680
    s_movk_i32 s60, 0x3ff
    s_waitcnt lgkmcnt(0)
    v_add_f32 v8, v8, v12
    v_add_f32 v16, v16, v20
    v_add_f32 v8, v8, v16
    v_bfi_b32 v192, s60, v226, v8
    v_add_f32 v9, v9, v13
    v_add_f32 v17, v17, v21
    v_add_f32 v9, v9, v17
    v_bfi_b32 v193, s60, v226, v9
    v_add_f32 v10, v10, v14
    v_add_f32 v18, v18, v22
    v_add_f32 v10, v10, v18
    v_bfi_b32 v194, s60, v226, v10
    v_add_f32 v11, v11, v15
    v_add_f32 v19, v19, v23
    v_add_f32 v11, v11, v19
    v_bfi_b32 v195, s60, v226, v11
    ds_write_b128 v6, v[192:195] offset:7936
    v_mov_b32 v24, 1576
    v_mov_b32 v25, 1
    s_waitcnt lgkmcnt(0)
    ds_write_b32 v24, v25
L_hy_done:
    s_cmp_lg_u32 s3, 3
    s_cbranch_scc1 L_mon_done
    s_setprio 3
    v_mov_b32 v14, 1548
    s_and_b32 s65, s2, 7
    s_mul_i32 s65, s65, 4352
    s_lshr_b32 s61, s2, 3
    s_lshl_b32 s61, s61, 2
    s_add_u32 s61, s61, s65
    v_mov_b32 v16, s61
    v_add_u32 v21, s65, v5
    v_cmp_gt_u32 vcc, 8, v1
    v_mov_b32 v22, 0x80000000
    s_mov_b32 s69, 0xffff
    v_cndmask_b32 v21, v22, v21, vcc
    v_lshrrev_b32 v23, 31, v21
    v_mov_b32 v19, 0x44800000
    v_mov_b32 v20, 0xc4800000
    s_mov_b32 s60, 470588
L_wt_1:
    ds_read_b32 v15, v14
    s_sub_u32 s60, s60, 1
    s_cselect_b32 s64, 0, 147
    s_waitcnt lgkmcnt(0)
    v_readfirstlane_b32 s63, v15
    s_cmp_ge_u32 s63, s64
    s_cbranch_scc1 L_wt_1x
    s_sleep 32
    s_branch L_wt_1
L_wt_1x:
    s_mov_b32 s60, 8000000
L_wt_2:
    ds_read_b32 v15, v14
    s_sub_u32 s60, s60, 1
    s_cselect_b32 s64, 0, 150
    s_waitcnt lgkmcnt(0)
    v_readfirstlane_b32 s63, v15
    s_cmp_ge_u32 s63, s64
    s_cbranch_scc1 L_wt_2x
    s_sleep 1
    s_branch L_wt_2
L_wt_2x:
    s_memrealtime s[66:67]
    s_and_b32 s61, s97, s69
    s_waitcnt lgkmcnt(0)
    s_lshl_b32 s66, s66, 16
    s_or_b32 s66, s66, s61
    v_mov_b32 v17, s66
    s_mov_b32 s61, 1376256
    s_mov_b64 exec, 1
    buffer_store_dword v17, v16, s[52:55], s61 offen
    s_mov_b64 exec, -1
    s_mov_b32 s60, 1600000
L_wt_3:
    ds_read_b32 v15, v14
    s_sub_u32 s60, s60, 1
    s_cselect_b32 s64, 0, 158
    s_waitcnt lgkmcnt(0)
    v_readfirstlane_b32 s63, v15
    s_cmp_ge_u32 s63, s64
    s_cbranch_scc1 L_wt_3x
    s_sleep 8
    s_branch L_wt_3
L_wt_3x:
    buffer_load_dwordx4 v[8:11], v21, s[52:55], s61 offen sc1
    v_mov_b32 v12, 0
    v_mov_b32 v13, 0
    s_waitcnt vmcnt(0)
    v_subrev_u32 v8, s66, v8
    v_and_or_b32 v18, v8, s69, v23
    v_ashrrev_i32 v8, 16, v8
    v_cmp_eq_u32 vcc, 0, v18
    v_cvt_f32_i32 v8, v8
    v_med3_f32 v8, v8, v20, v19
    v_cndmask_b32 v18, 0, 1.0, vcc
    v_add_f32 v13, v13, v18
    v_fmac_f32 v12, v18, v8
    v_subrev_u32 v9, s66, v9
    v_and_or_b32 v18, v9, s69, v23
    v_ashrrev_i32 v9, 16, v9
    v_cmp_eq_u32 vcc, 0, v18
    v_cvt_f32_i32 v9, v9
    v_med3_f32 v9, v9, v20, v19
    v_cndmask_b32 v18, 0, 1.0, vcc
    v_add_f32 v13, v13, v18
    v_fmac_f32 v12, v18, v9
    v_subrev_u32 v10, s66, v10
    v_and_or_b32 v18, v10, s69, v23
    v_ashrrev_i32 v10, 16, v10
    v_cmp_eq_u32 vcc, 0, v18
    v_cvt_f32_i32 v10, v10
    v_med3_f32 v10, v10, v20, v19
    v_cndmask_b32 v18, 0, 1.0, vcc
    v_add_f32 v13, v13, v18
    v_fmac_f32 v12, v18, v10
    v_subrev_u32 v11, s66, v11
    v_and_or_b32 v18, v11, s69, v23
    v_ashrrev_i32 v11, 16, v11
    v_cmp_eq_u32 vcc, 0, v18
    v_cvt_f32_i32 v11, v11
    v_med3_f32 v11, v11, v20, v19
    v_cndmask_b32 v18, 0, 1.0, vcc
    v_add_f32 v13, v13, v18
    v_fmac_f32 v12, v18, v11
    s_nop 1
    v_add_f32_dpp v12, v12, v12 row_ror:1 row_mask:0xf bank_mask:0xf
    v_add_f32_dpp v13, v13, v13 row_ror:1 row_mask:0xf bank_mask:0xf
    s_nop 0
    v_add_f32_dpp v12, v12, v12 row_ror:2 row_mask:0xf bank_mask:0xf
    v_add_f32_dpp v13, v13, v13 row_ror:2 row_mask:0xf bank_mask:0xf
    s_nop 0
    v_add_f32_dpp v12, v12, v12 row_ror:4 row_mask:0xf bank_mask:0xf
    v_add_f32_dpp v13, v13, v13 row_ror:4 row_mask:0xf bank_mask:0xf
    s_nop 0
    v_add_f32_dpp v12, v12, v12 row_ror:8 row_mask:0xf bank_mask:0xf
    v_add_f32_dpp v13, v13, v13 row_ror:8 row_mask:0xf bank_mask:0xf
    s_nop 0
    s_cmp_eq_u32 s99, -1
    s_cselect_b32 s61, 0, 0
    v_cvt_f32_i32 v18, s61
    ds_read_b32 v15, v14
    v_rcp_f32 v13, v13
    s_nop 0
    v_fma_f32 v12, -v12, v13, v18
    v_sub_f32 v13, 30.0, v12
    v_add_f32 v12, -10.0, v12
    v_mul_f32 v12, 0.328125, v12
    v_mul_f32 v13, 0, v13
    v_max_f32 v12, 0, v12
    v_max_f32 v13, 0, v13
    v_cvt_u32_f32 v12, v12
    v_cvt_u32_f32 v13, v13
    s_waitcnt lgkmcnt(0)
    v_add_u32 v12, v12, v15
    v_add_u32 v13, v13, v15
    v_min_u32 v12, 256, v12
    s_mov_b64 exec, 1
    ds_write_b64 v14, v[12:13] offset:44
    s_mov_b64 exec, -1
    s_mov_b32 s60, 470588
L_wt_4:
    ds_read_b32 v15, v14
    s_sub_u32 s60, s60, 1
    s_cselect_b32 s64, 0, 253
    s_waitcnt lgkmcnt(0)
    v_readfirstlane_b32 s63, v15
    s_cmp_ge_u32 s63, s64
    s_cbranch_scc1 L_wt_4x
    s_sleep 32
    s_branch L_wt_4
L_wt_4x:
    s_mov_b32 s60, 8000000
L_wt_5:
    ds_read_b32 v15, v14
    s_sub_u32 s60, s60, 1
    s_cselect_b32 s64, 0, 256
    s_waitcnt lgkmcnt(0)
    v_readfirstlane_b32 s63, v15
    s_cmp_ge_u32 s63, s64
    s_cbranch_scc1 L_wt_5x
    s_sleep 1
    s_branch L_wt_5
L_wt_5x:
    s_memrealtime s[66:67]
    s_and_b32 s61, s97, s69
    s_waitcnt lgkmcnt(0)
    s_lshl_b32 s66, s66, 16
    s_or_b32 s66, s66, s61
    v_mov_b32 v17, s66
    s_mov_b32 s61, 1376384
    s_mov_b64 exec, 1
    buffer_store_dword v17, v16, s[52:55], s61 offen
    s_mov_b64 exec, -1
    s_mov_b32 s60, 1600000
L_wt_6:
    ds_read_b32 v15, v14
    s_sub_u32 s60, s60, 1
    s_cselect_b32 s64, 0, 261
    s_waitcnt lgkmcnt(0)
    v_readfirstlane_b32 s63, v15
    s_cmp_ge_u32 s63, s64
    s_cbranch_scc1 L_wt_6x
    s_sleep 8
    s_branch L_wt_6
L_wt_6x:
    buffer_load_dwordx4 v[8:11], v21, s[52:55], s61 offen sc1
    v_mov_b32 v12, 0
    v_mov_b32 v13, 0
    s_waitcnt vmcnt(0)
    v_subrev_u32 v8, s66, v8
    v_and_or_b32 v18, v8, s69, v23
    v_ashrrev_i32 v8, 16, v8
    v_cmp_eq_u32 vcc, 0, v18
    v_cvt_f32_i32 v8, v8
    v_med3_f32 v8, v8, v20, v19
    v_cndmask_b32 v18, 0, 1.0, vcc
    v_add_f32 v13, v13, v18
    v_fmac_f32 v12, v18, v8
    v_subrev_u32 v9, s66, v9
    v_and_or_b32 v18, v9, s69, v23
    v_ashrrev_i32 v9, 16, v9
    v_cmp_eq_u32 vcc, 0, v18
    v_cvt_f32_i32 v9, v9
    v_med3_f32 v9, v9, v20, v19
    v_cndmask_b32 v18, 0, 1.0, vcc
    v_add_f32 v13, v13, v18
    v_fmac_f32 v12, v18, v9
    v_subrev_u32 v10, s66, v10
    v_and_or_b32 v18, v10, s69, v23
    v_ashrrev_i32 v10, 16, v10
    v_cmp_eq_u32 vcc, 0, v18
    v_cvt_f32_i32 v10, v10
    v_med3_f32 v10, v10, v20, v19
    v_cndmask_b32 v18, 0, 1.0, vcc
    v_add_f32 v13, v13, v18
    v_fmac_f32 v12, v18, v10
    v_subrev_u32 v11, s66, v11
    v_and_or_b32 v18, v11, s69, v23
    v_ashrrev_i32 v11, 16, v11
    v_cmp_eq_u32 vcc, 0, v18
    v_cvt_f32_i32 v11, v11
    v_med3_f32 v11, v11, v20, v19
    v_cndmask_b32 v18, 0, 1.0, vcc
    v_add_f32 v13, v13, v18
    v_fmac_f32 v12, v18, v11
    s_nop 1
    v_add_f32_dpp v12, v12, v12 row_ror:1 row_mask:0xf bank_mask:0xf
    v_add_f32_dpp v13, v13, v13 row_ror:1 row_mask:0xf bank_mask:0xf
    s_nop 0
    v_add_f32_dpp v12, v12, v12 row_ror:2 row_mask:0xf bank_mask:0xf
    v_add_f32_dpp v13, v13, v13 row_ror:2 row_mask:0xf bank_mask:0xf
    s_nop 0
    v_add_f32_dpp v12, v12, v12 row_ror:4 row_mask:0xf bank_mask:0xf
    v_add_f32_dpp v13, v13, v13 row_ror:4 row_mask:0xf bank_mask:0xf
    s_nop 0
    v_add_f32_dpp v12, v12, v12 row_ror:8 row_mask:0xf bank_mask:0xf
    v_add_f32_dpp v13, v13, v13 row_ror:8 row_mask:0xf bank_mask:0xf
    s_nop 0
    s_cmp_eq_u32 s99, -1
    s_cselect_b32 s61, 0, 0
    v_cvt_f32_i32 v18, s61
    ds_read_b32 v15, v14
    v_rcp_f32 v13, v13
    s_nop 0
    v_fma_f32 v12, -v12, v13, v18
    v_sub_f32 v13, 30.0, v12
    v_add_f32 v12, -10.0, v12
    v_mul_f32 v12, 0.328125, v12
    v_mul_f32 v13, 0.03125, v13
    v_max_f32 v12, 0, v12
    v_max_f32 v13, 0, v13
    v_cvt_u32_f32 v12, v12
    v_cvt_u32_f32 v13, v13
    s_waitcnt lgkmcnt(0)
    v_add_u32 v12, v12, v15
    v_add_u32 v13, v13, v15
    s_mov_b64 exec, 1
    ds_write_b64 v14, v[12:13] offset:44
    s_mov_b64 exec, -1
    s_mov_b32 s60, 470588
L_wt_7:
    ds_read_b32 v15, v14
    s_sub_u32 s60, s60, 1
    s_cselect_b32 s64, 0, 337
    s_waitcnt lgkmcnt(0)
    v_readfirstlane_b32 s63, v15
    s_cmp_ge_u32 s63, s64
    s_cbranch_scc1 L_wt_7x
    s_sleep 32
    s_branch L_wt_7
L_wt_7x:
    s_mov_b32 s60, 8000000
L_wt_8:
    ds_read_b32 v15, v14
    s_sub_u32 s60, s60, 1
    s_cselect_b32 s64, 0, 340
    s_waitcnt lgkmcnt(0)
    v_readfirstlane_b32 s63, v15
    s_cmp_ge_u32 s63, s64
    s_cbranch_scc1 L_wt_8x
    s_sleep 1
    s_branch L_wt_8
L_wt_8x:
    s_memrealtime s[66:67]
    s_and_b32 s61, s97, s69
    s_waitcnt lgkmcnt(0)
    s_lshl_b32 s66, s66, 16
    s_or_b32 s66, s66, s61
    v_mov_b32 v17, s66
    s_mov_b32 s61, 1376512
    s_mov_b64 exec, 1
    buffer_store_dword v17, v16, s[52:55], s61 offen
    s_mov_b64 exec, -1
    s_mov_b32 s60, 1600000
L_wt_9:
    ds_read_b32 v15, v14
    s_sub_u32 s60, s60, 1
    s_cselect_b32 s64, 0, 345
    s_waitcnt lgkmcnt(0)
    v_readfirstlane_b32 s63, v15
    s_cmp_ge_u32 s63, s64
    s_cbranch_scc1 L_wt_9x
    s_sleep 8
    s_branch L_wt_9
L_wt_9x:
    buffer_load_dwordx4 v[8:11], v21, s[52:55], s61 offen sc1
    v_mov_b32 v12, 0
    v_mov_b32 v13, 0
    s_waitcnt vmcnt(0)
    v_subrev_u32 v8, s66, v8
    v_and_or_b32 v18, v8, s69, v23
    v_ashrrev_i32 v8, 16, v8
    v_cmp_eq_u32 vcc, 0, v18
    v_cvt_f32_i32 v8, v8
    v_med3_f32 v8, v8, v20, v19
    v_cndmask_b32 v18, 0, 1.0, vcc
    v_add_f32 v13, v13, v18
    v_fmac_f32 v12, v18, v8
    v_subrev_u32 v9, s66, v9
    v_and_or_b32 v18, v9, s69, v23
    v_ashrrev_i32 v9, 16, v9
    v_cmp_eq_u32 vcc, 0, v18
    v_cvt_f32_i32 v9, v9
    v_med3_f32 v9, v9, v20, v19
    v_cndmask_b32 v18, 0, 1.0, vcc
    v_add_f32 v13, v13, v18
    v_fmac_f32 v12, v18, v9
    v_subrev_u32 v10, s66, v10
    v_and_or_b32 v18, v10, s69, v23
    v_ashrrev_i32 v10, 16, v10
    v_cmp_eq_u32 vcc, 0, v18
    v_cvt_f32_i32 v10, v10
    v_med3_f32 v10, v10, v20, v19
    v_cndmask_b32 v18, 0, 1.0, vcc
    v_add_f32 v13, v13, v18
    v_fmac_f32 v12, v18, v10
    v_subrev_u32 v11, s66, v11
    v_and_or_b32 v18, v11, s69, v23
    v_ashrrev_i32 v11, 16, v11
    v_cmp_eq_u32 vcc, 0, v18
    v_cvt_f32_i32 v11, v11
    v_med3_f32 v11, v11, v20, v19
    v_cndmask_b32 v18, 0, 1.0, vcc
    v_add_f32 v13, v13, v18
    v_fmac_f32 v12, v18, v11
    s_nop 1
    v_add_f32_dpp v12, v12, v12 row_ror:1 row_mask:0xf bank_mask:0xf
    v_add_f32_dpp v13, v13, v13 row_ror:1 row_mask:0xf bank_mask:0xf
    s_nop 0
    v_add_f32_dpp v12, v12, v12 row_ror:2 row_mask:0xf bank_mask:0xf
    v_add_f32_dpp v13, v13, v13 row_ror:2 row_mask:0xf bank_mask:0xf
    s_nop 0
    v_add_f32_dpp v12, v12, v12 row_ror:4 row_mask:0xf bank_mask:0xf
    v_add_f32_dpp v13, v13, v13 row_ror:4 row_mask:0xf bank_mask:0xf
    s_nop 0
    v_add_f32_dpp v12, v12, v12 row_ror:8 row_mask:0xf bank_mask:0xf
    v_add_f32_dpp v13, v13, v13 row_ror:8 row_mask:0xf bank_mask:0xf
    s_nop 0
    s_cmp_eq_u32 s99, -1
    s_cselect_b32 s61, 0, 0
    v_cvt_f32_i32 v18, s61
    ds_read_b32 v15, v14
    v_rcp_f32 v13, v13
    s_nop 0
    v_fma_f32 v12, -v12, v13, v18
    v_sub_f32 v13, 30.0, v12
    v_add_f32 v12, -10.0, v12
    v_mul_f32 v12, 0.328125, v12
    v_mul_f32 v13, 0.03125, v13
    v_max_f32 v12, 0, v12
    v_max_f32 v13, 0, v13
    v_cvt_u32_f32 v12, v12
    v_cvt_u32_f32 v13, v13
    s_waitcnt lgkmcnt(0)
    v_add_u32 v12, v12, v15
    v_add_u32 v13, v13, v15
    s_mov_b64 exec, 1
    ds_write_b64 v14, v[12:13] offset:44
    s_mov_b64 exec, -1
    s_mov_b32 s60, 470588
L_wt_10:
    ds_read_b32 v15, v14
    s_sub_u32 s60, s60, 1
    s_cselect_b32 s64, 0, 433
    s_waitcnt lgkmcnt(0)
    v_readfirstlane_b32 s63, v15
    s_cmp_ge_u32 s63, s64
    s_cbranch_scc1 L_wt_10x
    s_sleep 32
    s_branch L_wt_10
L_wt_10x:
    s_mov_b32 s60, 8000000
L_wt_11:
    ds_read_b32 v15, v14
    s_sub_u32 s60, s60, 1
    s_cselect_b32 s64, 0, 436
    s_waitcnt lgkmcnt(0)
    v_readfirstlane_b32 s63, v15
    s_cmp_ge_u32 s63, s64
    s_cbranch_scc1 L_wt_11x
    s_sleep 1
    s_branch L_wt_11
L_wt_11x:
    s_memrealtime s[66:67]
    s_and_b32 s61, s97, s69
    s_waitcnt lgkmcnt(0)
    s_lshl_b32 s66, s66, 16
    s_or_b32 s66, s66, s61
    v_mov_b32 v17, s66
    s_mov_b32 s61, 1376640
    s_mov_b64 exec, 1
    buffer_store_dword v17, v16, s[52:55], s61 offen
    s_mov_b64 exec, -1
    s_mov_b32 s60, 1600000
L_wt_12:
    ds_read_b32 v15, v14
    s_sub_u32 s60, s60, 1
    s_cselect_b32 s64, 0, 459
    s_waitcnt lgkmcnt(0)
    v_readfirstlane_b32 s63, v15
    s_cmp_ge_u32 s63, s64
    s_cbranch_scc1 L_wt_12x
    s_sleep 8
    s_branch L_wt_12
L_wt_12x:
    buffer_load_dwordx4 v[8:11], v21, s[52:55], s61 offen sc1
    v_mov_b32 v12, 0
    v_mov_b32 v13, 0
    s_waitcnt vmcnt(0)
    v_subrev_u32 v8, s66, v8
    v_and_or_b32 v18, v8, s69, v23
    v_ashrrev_i32 v8, 16, v8
    v_cmp_eq_u32 vcc, 0, v18
    v_cvt_f32_i32 v8, v8
    v_med3_f32 v8, v8, v20, v19
    v_cndmask_b32 v18, 0, 1.0, vcc
    v_add_f32 v13, v13, v18
    v_fmac_f32 v12, v18, v8
    v_subrev_u32 v9, s66, v9
    v_and_or_b32 v18, v9, s69, v23
    v_ashrrev_i32 v9, 16, v9
    v_cmp_eq_u32 vcc, 0, v18
    v_cvt_f32_i32 v9, v9
    v_med3_f32 v9, v9, v20, v19
    v_cndmask_b32 v18, 0, 1.0, vcc
    v_add_f32 v13, v13, v18
    v_fmac_f32 v12, v18, v9
    v_subrev_u32 v10, s66, v10
    v_and_or_b32 v18, v10, s69, v23
    v_ashrrev_i32 v10, 16, v10
    v_cmp_eq_u32 vcc, 0, v18
    v_cvt_f32_i32 v10, v10
    v_med3_f32 v10, v10, v20, v19
    v_cndmask_b32 v18, 0, 1.0, vcc
    v_add_f32 v13, v13, v18
    v_fmac_f32 v12, v18, v10
    v_subrev_u32 v11, s66, v11
    v_and_or_b32 v18, v11, s69, v23
    v_ashrrev_i32 v11, 16, v11
    v_cmp_eq_u32 vcc, 0, v18
    v_cvt_f32_i32 v11, v11
    v_med3_f32 v11, v11, v20, v19
    v_cndmask_b32 v18, 0, 1.0, vcc
    v_add_f32 v13, v13, v18
    v_fmac_f32 v12, v18, v11
    s_nop 1
    v_add_f32_dpp v12, v12, v12 row_ror:1 row_mask:0xf bank_mask:0xf
    v_add_f32_dpp v13, v13, v13 row_ror:1 row_mask:0xf bank_mask:0xf
    s_nop 0
    v_add_f32_dpp v12, v12, v12 row_ror:2 row_mask:0xf bank_mask:0xf
    v_add_f32_dpp v13, v13, v13 row_ror:2 row_mask:0xf bank_mask:0xf
    s_nop 0
    v_add_f32_dpp v12, v12, v12 row_ror:4 row_mask:0xf bank_mask:0xf
    v_add_f32_dpp v13, v13, v13 row_ror:4 row_mask:0xf bank_mask:0xf
    s_nop 0
    v_add_f32_dpp v12, v12, v12 row_ror:8 row_mask:0xf bank_mask:0xf
    v_add_f32_dpp v13, v13, v13 row_ror:8 row_mask:0xf bank_mask:0xf
    s_nop 0
    s_cmp_eq_u32 s99, -1
    s_cselect_b32 s61, 0, 0
    v_cvt_f32_i32 v18, s61
    ds_read_b32 v15, v14
    v_rcp_f32 v13, v13
    s_nop 0
    v_fma_f32 v12, -v12, v13, v18
    v_sub_f32 v13, 30.0, v12
    v_add_f32 v12, -10.0, v12
    v_mul_f32 v12, 0.328125, v12
    v_mul_f32 v13, 0.03125, v13
    v_max_f32 v12, 0, v12
    v_max_f32 v13, 0, v13
    v_cvt_u32_f32 v12, v12
    v_cvt_u32_f32 v13, v13
    s_waitcnt lgkmcnt(0)
    v_add_u32 v12, v12, v15
    v_add_u32 v13, v13, v15
    s_mov_b64 exec, 1
    ds_write_b64 v14, v[12:13] offset:44
    s_mov_b64 exec, -1
    s_mov_b32 s60, 470588
L_wt_13:
    ds_read_b32 v15, v14
    s_sub_u32 s60, s60, 1
    s_cselect_b32 s64, 0, 469
    s_waitcnt lgkmcnt(0)
    v_readfirstlane_b32 s63, v15
    s_cmp_ge_u32 s63, s64
    s_cbranch_scc1 L_wt_13x
    s_sleep 32
    s_branch L_wt_13
L_wt_13x:
    s_mov_b32 s60, 8000000
L_wt_14:
    ds_read_b32 v15, v14
    s_sub_u32 s60, s60, 1
    s_cselect_b32 s64, 0, 472
    s_waitcnt lgkmcnt(0)
    v_readfirstlane_b32 s63, v15
    s_cmp_ge_u32 s63, s64
    s_cbranch_scc1 L_wt_14x
    s_sleep 1
    s_branch L_wt_14
L_wt_14x:
    s_memrealtime s[66:67]
    s_and_b32 s61, s97, s69
    s_waitcnt lgkmcnt(0)
    s_lshl_b32 s66, s66, 16
    s_or_b32 s66, s66, s61
    v_mov_b32 v17, s66
    s_mov_b32 s61, 1376768
    s_mov_b64 exec, 1
    buffer_store_dword v17, v16, s[52:55], s61 offen
    s_mov_b64 exec, -1
    s_mov_b32 s60, 1600000
L_wt_15:
    ds_read_b32 v15, v14
    s_sub_u32 s60, s60, 1
    s_cselect_b32 s64, 0, 486
    s_waitcnt lgkmcnt(0)
    v_readfirstlane_b32 s63, v15
    s_cmp_ge_u32 s63, s64
    s_cbranch_scc1 L_wt_15x
    s_sleep 8
    s_branch L_wt_15
L_wt_15x:
    buffer_load_dwordx4 v[8:11], v21, s[52:55], s61 offen sc1
    v_mov_b32 v12, 0
    v_mov_b32 v13, 0
    s_waitcnt vmcnt(0)
    v_subrev_u32 v8, s66, v8
    v_and_or_b32 v18, v8, s69, v23
    v_ashrrev_i32 v8, 16, v8
    v_cmp_eq_u32 vcc, 0, v18
    v_cvt_f32_i32 v8, v8
    v_med3_f32 v8, v8, v20, v19
    v_cndmask_b32 v18, 0, 1.0, vcc
    v_add_f32 v13, v13, v18
    v_fmac_f32 v12, v18, v8
    v_subrev_u32 v9, s66, v9
    v_and_or_b32 v18, v9, s69, v23
    v_ashrrev_i32 v9, 16, v9
    v_cmp_eq_u32 vcc, 0, v18
    v_cvt_f32_i32 v9, v9
    v_med3_f32 v9, v9, v20, v19
    v_cndmask_b32 v18, 0, 1.0, vcc
    v_add_f32 v13, v13, v18
    v_fmac_f32 v12, v18, v9
    v_subrev_u32 v10, s66, v10
    v_and_or_b32 v18, v10, s69, v23
    v_ashrrev_i32 v10, 16, v10
    v_cmp_eq_u32 vcc, 0, v18
    v_cvt_f32_i32 v10, v10
    v_med3_f32 v10, v10, v20, v19
    v_cndmask_b32 v18, 0, 1.0, vcc
    v_add_f32 v13, v13, v18
    v_fmac_f32 v12, v18, v10
    v_subrev_u32 v11, s66, v11
    v_and_or_b32 v18, v11, s69, v23
    v_ashrrev_i32 v11, 16, v11
    v_cmp_eq_u32 vcc, 0, v18
    v_cvt_f32_i32 v11, v11
    v_med3_f32 v11, v11, v20, v19
    v_cndmask_b32 v18, 0, 1.0, vcc
    v_add_f32 v13, v13, v18
    v_fmac_f32 v12, v18, v11
    s_nop 1
    v_add_f32_dpp v12, v12, v12 row_ror:1 row_mask:0xf bank_mask:0xf
    v_add_f32_dpp v13, v13, v13 row_ror:1 row_mask:0xf bank_mask:0xf
    s_nop 0
    v_add_f32_dpp v12, v12, v12 row_ror:2 row_mask:0xf bank_mask:0xf
    v_add_f32_dpp v13, v13, v13 row_ror:2 row_mask:0xf bank_mask:0xf
    s_nop 0
    v_add_f32_dpp v12, v12, v12 row_ror:4 row_mask:0xf bank_mask:0xf
    v_add_f32_dpp v13, v13, v13 row_ror:4 row_mask:0xf bank_mask:0xf
    s_nop 0
    v_add_f32_dpp v12, v12, v12 row_ror:8 row_mask:0xf bank_mask:0xf
    v_add_f32_dpp v13, v13, v13 row_ror:8 row_mask:0xf bank_mask:0xf
    s_nop 0
    s_cmp_eq_u32 s99, -1
    s_cselect_b32 s61, 0, 45
    v_cvt_f32_i32 v18, s61
    ds_read_b32 v15, v14
    v_rcp_f32 v13, v13
    s_nop 0
    v_fma_f32 v12, -v12, v13, v18
    v_sub_f32 v13, 30.0, v12
    v_add_f32 v12, -10.0, v12
    v_mul_f32 v12, 0.328125, v12
    v_mul_f32 v13, 0.03125, v13
    v_max_f32 v12, 0, v12
    v_max_f32 v13, 0, v13
    v_cvt_u32_f32 v12, v12
    v_cvt_u32_f32 v13, v13
    s_waitcnt lgkmcnt(0)
    v_add_u32 v12, v12, v15
    v_add_u32 v13, v13, v15
    s_mov_b64 exec, 1
    ds_write_b64 v14, v[12:13] offset:44
    s_mov_b64 exec, -1
L_mon_done:
    s_cmp_eq_u32 s99, -1
    s_cbranch_scc1 L_fin
    s_setprio 0
    v_and_b32 v2, 15, v1
    v_lshrrev_b32 v3, 4, v1
    v_lshlrev_b32 v4, 13, v3
    v_and_b32 v5, 3, v1
    v_lshl_add_u32 v5, v5, 11, v4
    v_lshl_add_u32 v4, v2, 4, v4
    s_lshl_b32 s64, s28, 15
    s_add_u32 s64, s64, 65536
    s_lshr_b32 s61, s3, 1
    s_lshl_b32 s61, s61, 4
    s_add_u32 s62, s64, s61
    s_lshl_b32 s61, s3, 8
    s_add_u32 s64, s64, s61
    s_add_u32 s63, s64, 4096
    s_lshl_b32 s65, s99, 4
    s_add_u32 s65, s65, s28
    s_lshl_b32 s65, s65, 11
    s_add_u32 s65, s65, 1048576
    s_add_u32 s66, s65, s61
    s_mov_b64 s[68:69], s[62:63]
    s_mov_b32 s70, s64
    v_mov_b32 v14, 1548
    s_lshl_b32 s31, s28, 2
    s_add_u32 s31, s31, s3
    s_mul_i32 s31, s31, 73728
    s_lshl_b32 s61, s99, 7
    s_add_u32 s31, s31, s61
    v_and_b32 v200, 8, v1
    v_lshl_add_u32 v200, v200, 2, v3
    v_mul_u32_u24 v200, 1152, v200
    v_and_b32 v201, 7, v1
    v_lshl_add_u32 v200, v201, 4, v200
    s_mov_b32 s60, 888888
L_wt_16:
    ds_read_b32 v15, v14
    s_sub_u32 s60, s60, 1
    s_cselect_b32 s64, 0, 520
    s_waitcnt lgkmcnt(0)
    v_readfirstlane_b32 s63, v15
    s_cmp_ge_u32 s63, s64
    s_cbranch_scc1 L_wt_16x
    s_sleep 16
    s_branch L_wt_16
L_wt_16x:
    s_mov_b32 s60, 4000000
L_wt_17:
    ds_read_b32 v15, v14
    s_sub_u32 s60, s60, 1
    s_cselect_b32 s64, 0, 526
    s_waitcnt lgkmcnt(0)
    v_readfirstlane_b32 s63, v15
    s_cmp_ge_u32 s63, s64
    s_cbranch_scc1 L_wt_17x
    s_sleep 2
    s_branch L_wt_17
L_wt_17x:
    buffer_load_dwordx4 v[116:119], v200, s[48:51], s31 offen
    s_add_u32 s31, s31, 4608
    buffer_load_dwordx4 v[120:123], v200, s[48:51], s31 offen
    s_add_u32 s31, s31, 4608
    buffer_load_dwordx4 v[124:127], v200, s[48:51], s31 offen
    s_add_u32 s31, s31, 4608
    buffer_load_dwordx4 v[128:131], v200, s[48:51], s31 offen
    s_add_u32 s31, s31, 4608
    buffer_load_dwordx4 v[132:135], v200, s[48:51], s31 offen
    s_add_u32 s31, s31, 4608
    buffer_load_dwordx4 v[136:139], v200, s[48:51], s31 offen
    s_add_u32 s31, s31, 4608
    buffer_load_dwordx4 v[140:143], v200, s[48:51], s31 offen
    s_add_u32 s31, s31, 4608
    buffer_load_dwordx4 v[144:147], v200, s[48:51], s31 offen
    s_mov_b64 s[62:63], s[68:69]
    s_mov_b32 s64, s70
    v_mov_b32 v14, 1572
    s_mov_b32 s49, 8000000
L_pub_wait:
    ds_read_b32 v15, v14
    s_sub_u32 s49, s49, 1
    s_cselect_b32 s60, 0, 1
    s_waitcnt lgkmcnt(0)
    v_readfirstlane_b32 s61, v15
    s_cmp_ge_u32 s61, s60
    s_cbranch_scc1 L_pub_ok
    s_sleep 1
    s_branch L_pub_wait
L_pub_ok:
    s_mov_b32 s49, 2000000
    s_movk_i32 s60, 0x3ff
L_g_poll:
    buffer_load_dwordx4 v[8:11], v5, s[52:55], s62 offen offset:1024 sc1
    buffer_load_dwordx4 v[12:15], v4, s[52:55], s64 offen sc1
    buffer_load_dwordx4 v[16:19], v4, s[52:55], s64 offen offset:2048 sc1
    buffer_load_dwordx4 v[20:23], v4, s[52:55], s63 offen sc1
    buffer_load_dwordx4 v[24:27], v4, s[52:55], s63 offen offset:2048 sc1
    s_sub_u32 s49, s49, 1
    s_cselect_b32 s60, 0, s60
    s_mov_b64 exec, -1
    s_waitcnt vmcnt(4)
    v_xor_b32 v33, s97, v10
    v_max_f32_dpp v28, v8, v8 quad_perm:[1,0,3,2] row_mask:0xf bank_mask:0xf
    v_bitop3_b32 v33, v33, v11, s97 bitop3:0xf6
    s_waitcnt vmcnt(3)
    v_xor_b32 v32, s97, v12
    v_max_f32_dpp v28, v28, v28 quad_perm:[2,3,0,1] row_mask:0xf bank_mask:0xf
    v_bitop3_b32 v32, v32, v13, s97 bitop3:0xf6
    v_mov_b32 v29, v28
    v_bitop3_b32 v32, v32, v14, s97 bitop3:0xf6
    v_bitop3_b32 v32, v32, v15, s97 bitop3:0xf6
    v_permlane16_swap_b32 v29, v28
    s_waitcnt vmcnt(2)
    v_bitop3_b32 v32, v32, v16, s97 bitop3:0xf6
    v_max_f32 v28, v28, v29
    v_bitop3_b32 v32, v32, v17, s97 bitop3:0xf6
    v_mov_b32 v29, v28
    v_bitop3_b32 v32, v32, v18, s97 bitop3:0xf6
    v_bitop3_b32 v32, v32, v19, s97 bitop3:0xf6
    v_permlane32_swap_b32 v29, v28
    s_waitcnt vmcnt(1)
    v_bitop3_b32 v32, v32, v20, s97 bitop3:0xf6
    v_max_f32 v28, v28, v29
    v_bitop3_b32 v32, v32, v21, s97 bitop3:0xf6
    v_sub_f32 v28, v8, v28
    v_bitop3_b32 v32, v32, v22, s97 bitop3:0xf6
    v_exp_f32 v28, v28
    v_bitop3_b32 v32, v32, v23, s97 bitop3:0xf6
    s_waitcnt vmcnt(0)
    v_bitop3_b32 v32, v32, v24, s97 bitop3:0xf6
    v_mul_f32 v30, v28, v9
    v_bitop3_b32 v32, v32, v25, s97 bitop3:0xf6
    v_bitop3_b32 v32, v32, v26, s97 bitop3:0xf6
    v_add_f32_dpp v30, v30, v30 quad_perm:[1,0,3,2] row_mask:0xf bank_mask:0xf
    v_bitop3_b32 v32, v32, v27, s97 bitop3:0xf6
    v_or_b32 v32, v32, v33
    v_lshrrev_b32 v33, 10, v33
    v_add_f32_dpp v30, v30, v30 quad_perm:[2,3,0,1] row_mask:0xf bank_mask:0xf
    v_min_u32 v33, s60, v33
    v_and_or_b32 v32, v32, s60, v33
    v_cmp_ne_u32 vcc, 0, v32
    s_and_b64 exec, exec, vcc
    s_cbranch_execz L_g_ok
    s_branch L_g_poll
L_g_ok:
    s_mov_b64 exec, -1
    v_mov_b32 v31, v30
    v_mul_f32_dpp v32, v28, v12 quad_perm:[0,0,0,0] row_mask:0xf bank_mask:0xf
    v_mul_f32_dpp v33, v28, v13 quad_perm:[0,0,0,0] row_mask:0xf bank_mask:0xf
    v_mul_f32_dpp v34, v28, v14 quad_perm:[0,0,0,0] row_mask:0xf bank_mask:0xf
    v_mul_f32_dpp v35, v28, v15 quad_perm:[0,0,0,0] row_mask:0xf bank_mask:0xf
    v_permlane16_swap_b32 v31, v30
    v_fmac_f32_dpp v32, v28, v16 quad_perm:[1,1,1,1] row_mask:0xf bank_mask:0xf
    v_fmac_f32_dpp v33, v28, v17 quad_perm:[1,1,1,1] row_mask:0xf bank_mask:0xf
    v_fmac_f32_dpp v34, v28, v18 quad_perm:[1,1,1,1] row_mask:0xf bank_mask:0xf
    v_fmac_f32_dpp v35, v28, v19 quad_perm:[1,1,1,1] row_mask:0xf bank_mask:0xf
    v_add_f32 v30, v30, v31
    v_mov_b32 v31, v30
    v_fmac_f32_dpp v32, v28, v20 quad_perm:[2,2,2,2] row_mask:0xf bank_mask:0xf
    v_fmac_f32_dpp v33, v28, v21 quad_perm:[2,2,2,2] row_mask:0xf bank_mask:0xf
    v_fmac_f32_dpp v34, v28, v22 quad_perm:[2,2,2,2] row_mask:0xf bank_mask:0xf
    v_fmac_f32_dpp v35, v28, v23 quad_perm:[2,2,2,2] row_mask:0xf bank_mask:0xf
    v_permlane32_swap_b32 v31, v30
    v_fmac_f32_dpp v32, v28, v24 quad_perm:[3,3,3,3] row_mask:0xf bank_mask:0xf
    v_fmac_f32_dpp v33, v28, v25 quad_perm:[3,3,3,3] row_mask:0xf bank_mask:0xf
    v_fmac_f32_dpp v34, v28, v26 quad_perm:[3,3,3,3] row_mask:0xf bank_mask:0xf
    v_fmac_f32_dpp v35, v28, v27 quad_perm:[3,3,3,3] row_mask:0xf bank_mask:0xf
    v_add_f32 v30, v30, v31
    v_permlane16_swap_b32 v32, v33
    v_rcp_f32 v30, v30
    v_permlane16_swap_b32 v34, v35
    v_add_f32 v32, v32, v33
    s_nop 0
    v_add_f32 v34, v34, v35
    s_nop 1
    v_permlane32_swap_b32 v32, v34
    s_movk_i32 s60, 0x3ff
    v_add_f32 v32, v32, v34
    v_mul_f32 v32, v32, v30
    v_cvt_pk_bf16_f32 v32, v32, v32
    s_nop 1
    v_mov_b32_dpp v8, v32 row_newbcast:0 row_mask:0xf bank_mask:0x3
    v_mov_b32_dpp v9, v32 row_newbcast:1 row_mask:0xf bank_mask:0x3
    v_mov_b32_dpp v10, v32 row_newbcast:2 row_mask:0xf bank_mask:0x3
    v_mov_b32_dpp v11, v32 row_newbcast:3 row_mask:0xf bank_mask:0x3
    v_mov_b32_dpp v12, v32 row_newbcast:4 row_mask:0xf bank_mask:0x3
    v_mov_b32_dpp v13, v32 row_newbcast:5 row_mask:0xf bank_mask:0x3
    v_mov_b32_dpp v14, v32 row_newbcast:6 row_mask:0xf bank_mask:0x3
    v_mov_b32_dpp v15, v32 row_newbcast:7 row_mask:0xf bank_mask:0x3
    v_mov_b32_dpp v8, v32 row_newbcast:8 row_mask:0xf bank_mask:0xc
    v_mov_b32_dpp v9, v32 row_newbcast:9 row_mask:0xf bank_mask:0xc
    v_mov_b32_dpp v10, v32 row_newbcast:10 row_mask:0xf bank_mask:0xc
    v_mov_b32_dpp v11, v32 row_newbcast:11 row_mask:0xf bank_mask:0xc
    v_mov_b32_dpp v12, v32 row_newbcast:12 row_mask:0xf bank_mask:0xc
    v_mov_b32_dpp v13, v32 row_newbcast:13 row_mask:0xf bank_mask:0xc
    v_mov_b32_dpp v14, v32 row_newbcast:14 row_mask:0xf bank_mask:0xc
    v_mov_b32_dpp v15, v32 row_newbcast:15 row_mask:0xf bank_mask:0xc
    v_and_b32 v16, v8, v188
    v_and_b32 v17, v8, v189
    v_and_b32 v18, v8, v190
    v_and_b32 v19, v8, v191
    v_and_b32 v20, v9, v188
    v_and_b32 v21, v9, v189
    v_mfma_f32_16x16x32_bf16 v[24:27], v[16:19], v[116:119], 0
    v_and_b32 v22, v9, v190
    v_and_b32 v23, v9, v191
    v_and_b32 v16, v10, v188
    v_and_b32 v17, v10, v189
    v_mfma_f32_16x16x32_bf16 v[24:27], v[20:23], v[120:123], v[24:27]
    v_and_b32 v18, v10, v190
    v_and_b32 v19, v10, v191
    v_and_b32 v20, v11, v188
    v_and_b32 v21, v11, v189
    v_mfma_f32_16x16x32_bf16 v[24:27], v[16:19], v[124:127], v[24:27]
    v_and_b32 v22, v11, v190
    v_and_b32 v23, v11, v191
    v_and_b32 v16, v12, v188
    v_and_b32 v17, v12, v189
    v_mfma_f32_16x16x32_bf16 v[24:27], v[20:23], v[128:131], v[24:27]
    v_and_b32 v18, v12, v190
    v_and_b32 v19, v12, v191
    v_and_b32 v20, v13, v188
    v_and_b32 v21, v13, v189
    v_mfma_f32_16x16x32_bf16 v[24:27], v[16:19], v[132:135], v[24:27]
    v_and_b32 v22, v13, v190
    v_and_b32 v23, v13, v191
    v_and_b32 v16, v14, v188
    v_and_b32 v17, v14, v189
    v_mfma_f32_16x16x32_bf16 v[24:27], v[20:23], v[136:139], v[24:27]
    v_and_b32 v18, v14, v190
    v_and_b32 v19, v14, v191
    v_and_b32 v20, v15, v188
    v_and_b32 v21, v15, v189
    v_mfma_f32_16x16x32_bf16 v[24:27], v[16:19], v[140:143], v[24:27]
    v_and_b32 v22, v15, v190
    v_and_b32 v23, v15, v191
    s_nop 1
    v_mfma_f32_16x16x32_bf16 v[24:27], v[20:23], v[144:147], v[24:27]
    s_nop 7
    v_mov_b32 v28, v24
    v_mov_b32 v29, v25
    v_mov_b32 v30, v26
    v_mov_b32 v31, v27
    v_permlane32_swap_b32 v28, v24
    v_permlane32_swap_b32 v29, v25
    v_permlane32_swap_b32 v30, v26
    v_permlane32_swap_b32 v31, v27
    v_add_f32_dpp v28, v24, v28 row_ror:8 row_mask:0xf bank_mask:0xf
    v_add_f32_dpp v29, v25, v29 row_ror:8 row_mask:0xf bank_mask:0xf
    v_add_f32_dpp v30, v26, v30 row_ror:8 row_mask:0xf bank_mask:0xf
    v_add_f32_dpp v31, v27, v31 row_ror:8 row_mask:0xf bank_mask:0xf
    s_lshl_b32 s61, s3, 8
    v_add_u32 v7, s61, v6
    v_mov_b32 v13, 1600
    v_mov_b32 v14, 1
    s_mov_b32 exec_lo, 0xff00ff
    s_mov_b32 exec_hi, 0x0
    ds_write_b128 v7, v[28:31] offset:24576
    s_mov_b64 exec, 1
    ds_add_rtn_u32 v15, v13, v14
    s_mov_b64 exec, -1
    s_waitcnt lgkmcnt(0)
    v_readfirstlane_b32 s61, v15
    s_cmp_lg_u32 s61, 3
    s_cbranch_scc1 L_fin
    ds_read_b128 v[8:11], v6 offset:24576
    ds_read_b128 v[12:15], v6 offset:24832
    ds_read_b128 v[16:19], v6 offset:25088
    ds_read_b128 v[20:23], v6 offset:25344
    s_mov_b32 s66, s65
    s_waitcnt lgkmcnt(2)
    v_pk_add_f32 v[8:9], v[8:9], v[12:13]
    v_pk_add_f32 v[10:11], v[10:11], v[14:15]
    s_waitcnt lgkmcnt(0)
    v_pk_add_f32 v[16:17], v[16:17], v[20:21]
    v_pk_add_f32 v[18:19], v[18:19], v[22:23]
    v_pk_add_f32 v[28:29], v[8:9], v[16:17]
    v_pk_add_f32 v[30:31], v[10:11], v[18:19]
    v_bfi_b32 v28, s60, v226, v28
    v_bfi_b32 v29, s60, v226, v29
    v_bfi_b32 v30, s60, v226, v30
    v_bfi_b32 v31, s60, v226, v31
    s_mov_b32 exec_lo, 0xff00ff
    s_mov_b32 exec_hi, 0x0
    buffer_store_dwordx4 v[28:31], v6, s[52:55], s66 offen sc1
    s_mov_b64 exec, -1
    s_branch L_fin
L_main:
    s_mov_b32 s52, s26
    s_mov_b32 s53, s27
    s_mov_b32 s54, 1572864
    s_mov_b32 s55, 0x20000
    v_and_b32 v7, 7, v1
    v_lshrrev_b32 v11, 1, v7
    v_and_b32 v7, 1, v7
    v_mov_b32 v12, 0xffff
    v_lshlrev_b32 v7, 4, v7
    v_lshlrev_b32 v7, v7, v12
    v_cmp_eq_u32 vcc, 0, v11
    s_nop 1
    v_cndmask_b32 v40, 0, v7, vcc
    v_cmp_eq_u32 vcc, 1, v11
    s_nop 1
    v_cndmask_b32 v41, 0, v7, vcc
    v_cmp_eq_u32 vcc, 2, v11
    s_nop 1
    v_cndmask_b32 v42, 0, v7, vcc
    v_cmp_eq_u32 vcc, 3, v11
    s_nop 1
    v_cndmask_b32 v43, 0, v7, vcc
    v_and_b32 v242, 1, v3
    v_lshrrev_b32 v243, 1, v3
    v_lshlrev_b32 v5, 20, v242
    v_lshl_add_u32 v5, v243, 14, v5
    v_and_b32 v242, 1, v3
    v_lshrrev_b32 v243, 1, v3
    v_lshlrev_b32 v244, 12, v242
    v_lshl_add_u32 v244, v243, 14, v244
    v_and_b32 v242, 1, v3
    v_lshrrev_b32 v243, 1, v3
    v_lshlrev_b32 v245, 11, v242
    v_lshl_add_u32 v245, v243, 14, v245
    v_bfe_u32 v7, v1, 3, 1
    v_lshlrev_b32 v11, 13, v7
    v_lshrrev_b32 v244, 7, v244
    v_add_u32 v244, v244, v11
    v_lshrrev_b32 v245, 7, v245
    v_add_u32 v245, v245, v11
    v_lshl_add_u32 v5, v2, 4, v5
    v_lshrrev_b32 v11, 2, v2
    v_lshl_add_u32 v248, v11, 8, v5
    v_add_u32 v11, 1, v11
    v_and_b32 v11, 3, v11
    v_lshl_add_u32 v249, v11, 8, v5
    v_add_u32 v11, 1, v11
    v_and_b32 v11, 3, v11
    v_lshl_add_u32 v250, v11, 8, v5
    v_add_u32 v11, 1, v11
    v_and_b32 v11, 3, v11
    v_lshl_add_u32 v251, v11, 8, v5
    v_lshlrev_b32 v242, 8, v7
    v_and_b32 v243, 0xff, v6
    v_add_u32 v243, v242, v243
    v_lshl_add_u32 v242, v3, 4, v242
    s_getreg_b32 s63, hwreg(HW_REG_XCC_ID, 0, 1)
    s_cmp_eq_u32 s63, 0
    s_mov_b32 s67, 43690
    s_mov_b32 s69, 44714
    s_cselect_b32 s67, 43690, s67
    s_cselect_b32 s69, 43690, s69
    v_mov_b32 v8, 0
    v_mov_b32 v44, 0
    v_mov_b32 v45, 0
    v_mov_b32 v46, 0
    v_mov_b32 v47, 0
    s_mov_b32 s48, 1069066811
    s_mov_b32 s49, 8000000
    s_mov_b32 s64, 0
    s_mov_b32 s71, 1
    s_mov_b32 s72, 1
    s_mov_b32 s73, 1
    s_mov_b32 s74, 1
    s_nop 0
    s_mov_b32 s84, 0x01010101
    s_mov_b32 s85, s84
    s_mov_b32 s88, 0xff00ff00
    s_mov_b32 s89, s88
    s_mov_b32 s90, 0xf0f0f0f0
    s_mov_b32 s91, s90
    v_mov_b32 v241, 1
    s_or_b32 s63, s45, 0x400
    buffer_load_dwordx4 v[128:131], v6, s[32:35], s63 offen offset:0 nt
    buffer_load_dwordx4 v[132:135], v6, s[32:35], s63 offen offset:256 nt
    buffer_load_dwordx4 v[136:139], v6, s[32:35], s63 offen offset:512 nt
    buffer_load_dwordx4 v[140:143], v6, s[32:35], s63 offen offset:768 nt
    s_or_b32 s11, s44, 0x400
    s_or_b32 s63, s45, 0x10400
    buffer_load_dwordx4 v[144:147], v6, s[32:35], s63 offen offset:0 nt
    buffer_load_dwordx4 v[148:151], v6, s[32:35], s63 offen offset:256 nt
    buffer_load_dwordx4 v[152:155], v6, s[32:35], s63 offen offset:512 nt
    buffer_load_dwordx4 v[156:159], v6, s[32:35], s63 offen offset:768 nt
    s_or_b32 s12, s44, 0x10400
    s_or_b32 s63, s45, 0x100400
    buffer_load_dwordx4 v[160:163], v6, s[32:35], s63 offen offset:0 nt
    buffer_load_dwordx4 v[164:167], v6, s[32:35], s63 offen offset:256 nt
    buffer_load_dwordx4 v[168:171], v6, s[32:35], s63 offen offset:512 nt
    buffer_load_dwordx4 v[172:175], v6, s[32:35], s63 offen offset:768 nt
    s_or_b32 s13, s44, 0xc00
    s_or_b32 s63, s45, 0x110400
    buffer_load_dwordx4 v[176:179], v6, s[32:35], s63 offen offset:0 nt
    buffer_load_dwordx4 v[180:183], v6, s[32:35], s63 offen offset:256 nt
    buffer_load_dwordx4 v[184:187], v6, s[32:35], s63 offen offset:512 nt
    buffer_load_dwordx4 v[188:191], v6, s[32:35], s63 offen offset:768 nt
    s_or_b32 s14, s44, 0x10c00
    s_or_b32 s62, s44, 0x20000
L_mq_lds:
    ds_read_b32 v7, v240 offset:8
    s_sub_u32 s49, s49, 1
    s_cselect_b32 s50, 0, 4
    s_waitcnt lgkmcnt(0)
    v_readfirstlane_b32 s63, v7
    s_cmp_ge_u32 s63, s50
    s_cbranch_scc1 L_mq_go
    s_sleep 1
    s_branch L_mq_lds
L_mq_go:
    ds_read_b32 v11, v240 offset:20
    ds_read_b32 v7, v240 offset:16
    ds_read_b128 v[16:19], v242 offset:1792
    ds_read_b128 v[20:23], v242 offset:1856
    ds_read_b128 v[24:27], v242 offset:1920
    ds_read_b128 v[28:31], v242 offset:1984
    ds_read_b128 v[12:15], v243 offset:1792
    v_mov_b32 v240, 1548
    s_waitcnt lgkmcnt(0)
    v_readfirstlane_b32 s70, v7
    v_readfirstlane_b32 s97, v11
L_kloop:
    s_cmp_ge_u32 s40, 1048576
    s_cbranch_scc1 L_venter0
    s_mov_b64 exec, 1
    ds_add_rtn_u32 v7, v240, v241
    ds_read_b32 v11, v240 offset:44
    s_mov_b64 exec, -1
    s_mov_b32 s65, s40
    s_mov_b32 s40, s62
    s_and_b32 s63, s62, 1048575
    s_lshr_b32 s50, s63, 11
    s_and_b32 s50, s50, 1
    s_lshl_b32 s50, s50, 20
    s_bitset0_b32 s63, 11
    s_or_b32 s63, s63, s50
    s_mov_b32 s66, s72
    s_mov_b32 s72, s64
    s_cmp_lg_u32 s66, 0
    s_waitcnt vmcnt(8)
    s_cbranch_scc1 L_qkb0
    v_mfma_f32_16x16x32_bf16 v[32:35], v[64:67], v[16:19], 0
    v_mfma_f32_16x16x32_bf16 v[32:35], v[68:71], v[20:23], v[32:35]
    v_mfma_f32_16x16x32_bf16 v[32:35], v[72:75], v[24:27], v[32:35]
    v_mfma_f32_16x16x32_bf16 v[32:35], v[76:79], v[28:31], v[32:35]
L_qkd0:
    s_cmp_lg_u32 s64, 0
    s_cbranch_scc1 L_ldb0
    buffer_load_dwordx4 v[64:67], v4, s[32:35], s63 offen offset:0 nt
    buffer_load_dwordx4 v[68:71], v4, s[32:35], s63 offen offset:64 nt
    buffer_load_dwordx4 v[72:75], v4, s[32:35], s63 offen offset:128 nt
    buffer_load_dwordx4 v[76:79], v4, s[32:35], s63 offen offset:192 nt
L_ldd0:
    s_waitcnt lgkmcnt(0)
    v_readfirstlane_b32 s62, v7
    v_readfirstlane_b32 s68, v11
    s_nop 0
    s_cmp_ge_u32 s62, 256
    s_cbranch_scc1 L_nxv0
    s_bfe_u32 s50, s62, 0x40002
    s_bitcmp1_b32 s67, s50
    s_cselect_b32 s64, 1, 0
    s_cmp_lt_u32 s62, s68
    s_cselect_b32 s64, 1, s64
    s_and_b32 s50, s62, 0x1
    s_lshl_b32 s51, s50, 15
    s_and_b32 s50, s62, 0xff22
    s_lshl_b32 s50, s50, 12
    s_or_b32 s51, s51, s50
    s_and_b32 s50, s62, 0x4
    s_lshl_b32 s50, s50, 14
    s_or_b32 s51, s51, s50
    s_and_b32 s50, s62, 0x8
    s_lshl_b32 s50, s50, 8
    s_or_b32 s51, s51, s50
    s_and_b32 s50, s62, 0x10
    s_lshl_b32 s50, s50, 6
    s_or_b32 s51, s51, s50
    s_and_b32 s50, s62, 0x40
    s_lshl_b32 s50, s50, 13
    s_or_b32 s51, s51, s50
    s_and_b32 s50, s62, 0x80
    s_lshl_b32 s50, s50, 11
    s_or_b32 s51, s51, s50
    s_mov_b32 s62, s51
L_nxd0:
    s_cmp_lg_u32 s66, 0
    s_cbranch_scc1 L_red0
L_redd0:
    v_cvt_pk_bf16_f32 v36, v32, v33
    v_cvt_pk_bf16_f32 v37, v34, v35
    s_lshr_b32 s50, s65, 7
    v_lshlrev_b32 v32, 16, v36
    v_and_b32 v33, 0xffff0000, v36
    v_lshlrev_b32 v34, 16, v37
    v_and_b32 v35, 0xffff0000, v37
    v_mul_f32 v32, 0x3db504f3, v32
    v_mul_f32 v33, 0x3db504f3, v33
    v_mul_f32 v34, 0x3db504f3, v34
    v_mul_f32 v35, 0x3db504f3, v35
    v_add_u32 v246, s50, v244
    v_cvt_pk_bf16_f32 v36, v32, v33
    v_cvt_pk_bf16_f32 v37, v34, v35
    v_max3_f32 v9, v9, v32, v33
    v_max3_f32 v9, v9, v34, v35
    s_mov_b64 exec, s[84:85]
    ds_write_b64 v246, v[36:37] offset:8192
    s_mov_b64 exec, -1
    s_cmp_ge_u32 s41, 1048576
    s_cbranch_scc1 L_venter1
    s_mov_b64 exec, 1
    ds_add_rtn_u32 v7, v240, v241
    ds_read_b32 v11, v240 offset:44
    s_mov_b64 exec, -1
    s_mov_b32 s65, s41
    s_mov_b32 s41, s62
    s_and_b32 s63, s62, 1048575
    s_lshr_b32 s50, s63, 11
    s_and_b32 s50, s50, 1
    s_lshl_b32 s50, s50, 20
    s_bitset0_b32 s63, 11
    s_or_b32 s63, s63, s50
    s_mov_b32 s66, s73
    s_mov_b32 s73, s64
    s_cmp_lg_u32 s66, 0
    s_waitcnt vmcnt(8)
    s_cbranch_scc1 L_qkb1
    v_mfma_f32_16x16x32_bf16 v[32:35], v[80:83], v[16:19], 0
    v_mfma_f32_16x16x32_bf16 v[32:35], v[84:87], v[20:23], v[32:35]
    v_mfma_f32_16x16x32_bf16 v[32:35], v[88:91], v[24:27], v[32:35]
    v_mfma_f32_16x16x32_bf16 v[32:35], v[92:95], v[28:31], v[32:35]
L_qkd1:
    s_cmp_lg_u32 s64, 0
    s_cbranch_scc1 L_ldb1
    buffer_load_dwordx4 v[80:83], v4, s[32:35], s63 offen offset:0 nt
    buffer_load_dwordx4 v[84:87], v4, s[32:35], s63 offen offset:64 nt
    buffer_load_dwordx4 v[88:91], v4, s[32:35], s63 offen offset:128 nt
    buffer_load_dwordx4 v[92:95], v4, s[32:35], s63 offen offset:192 nt
L_ldd1:
    s_waitcnt lgkmcnt(0)
    v_readfirstlane_b32 s62, v7
    v_readfirstlane_b32 s68, v11
    s_nop 0
    s_cmp_ge_u32 s62, 256
    s_cbranch_scc1 L_nxv1
    s_bfe_u32 s50, s62, 0x40002
    s_bitcmp1_b32 s67, s50
    s_cselect_b32 s64, 1, 0
    s_cmp_lt_u32 s62, s68
    s_cselect_b32 s64, 1, s64
    s_and_b32 s50, s62, 0x1
    s_lshl_b32 s51, s50, 15
    s_and_b32 s50, s62, 0xff22
    s_lshl_b32 s50, s50, 12
    s_or_b32 s51, s51, s50
    s_and_b32 s50, s62, 0x4
    s_lshl_b32 s50, s50, 14
    s_or_b32 s51, s51, s50
    s_and_b32 s50, s62, 0x8
    s_lshl_b32 s50, s50, 8
    s_or_b32 s51, s51, s50
    s_and_b32 s50, s62, 0x10
    s_lshl_b32 s50, s50, 6
    s_or_b32 s51, s51, s50
    s_and_b32 s50, s62, 0x40
    s_lshl_b32 s50, s50, 13
    s_or_b32 s51, s51, s50
    s_and_b32 s50, s62, 0x80
    s_lshl_b32 s50, s50, 11
    s_or_b32 s51, s51, s50
    s_mov_b32 s62, s51
L_nxd1:
    s_cmp_lg_u32 s66, 0
    s_cbranch_scc1 L_red1
L_redd1:
    v_cvt_pk_bf16_f32 v36, v32, v33
    v_cvt_pk_bf16_f32 v37, v34, v35
    s_lshr_b32 s50, s65, 7
    v_lshlrev_b32 v32, 16, v36
    v_and_b32 v33, 0xffff0000, v36
    v_lshlrev_b32 v34, 16, v37
    v_and_b32 v35, 0xffff0000, v37
    v_mul_f32 v32, 0x3db504f3, v32
    v_mul_f32 v33, 0x3db504f3, v33
    v_mul_f32 v34, 0x3db504f3, v34
    v_mul_f32 v35, 0x3db504f3, v35
    v_add_u32 v246, s50, v244
    v_cvt_pk_bf16_f32 v36, v32, v33
    v_cvt_pk_bf16_f32 v37, v34, v35
    v_max3_f32 v9, v9, v32, v33
    v_max3_f32 v9, v9, v34, v35
    s_mov_b64 exec, s[84:85]
    ds_write_b64 v246, v[36:37] offset:8192
    s_mov_b64 exec, -1
    s_cmp_ge_u32 s42, 1048576
    s_cbranch_scc1 L_venter2
    s_mov_b64 exec, 1
    ds_add_rtn_u32 v7, v240, v241
    ds_read_b32 v11, v240 offset:44
    s_mov_b64 exec, -1
    s_mov_b32 s65, s42
    s_mov_b32 s42, s62
    s_and_b32 s63, s62, 1048575
    s_lshr_b32 s50, s63, 11
    s_and_b32 s50, s50, 1
    s_lshl_b32 s50, s50, 20
    s_bitset0_b32 s63, 11
    s_or_b32 s63, s63, s50
    s_mov_b32 s66, s74
    s_mov_b32 s74, s64
    s_cmp_lg_u32 s66, 0
    s_waitcnt vmcnt(8)
    s_cbranch_scc1 L_qkb2
    v_mfma_f32_16x16x32_bf16 v[32:35], v[96:99], v[16:19], 0
    v_mfma_f32_16x16x32_bf16 v[32:35], v[100:103], v[20:23], v[32:35]
    v_mfma_f32_16x16x32_bf16 v[32:35], v[104:107], v[24:27], v[32:35]
    v_mfma_f32_16x16x32_bf16 v[32:35], v[108:111], v[28:31], v[32:35]
L_qkd2:
    s_cmp_lg_u32 s64, 0
    s_cbranch_scc1 L_ldb2
    buffer_load_dwordx4 v[96:99], v4, s[32:35], s63 offen offset:0 nt
    buffer_load_dwordx4 v[100:103], v4, s[32:35], s63 offen offset:64 nt
    buffer_load_dwordx4 v[104:107], v4, s[32:35], s63 offen offset:128 nt
    buffer_load_dwordx4 v[108:111], v4, s[32:35], s63 offen offset:192 nt
L_ldd2:
    s_waitcnt lgkmcnt(0)
    v_readfirstlane_b32 s62, v7
    v_readfirstlane_b32 s68, v11
    s_nop 0
    s_cmp_ge_u32 s62, 256
    s_cbranch_scc1 L_nxv2
    s_bfe_u32 s50, s62, 0x40002
    s_bitcmp1_b32 s67, s50
    s_cselect_b32 s64, 1, 0
    s_cmp_lt_u32 s62, s68
    s_cselect_b32 s64, 1, s64
    s_and_b32 s50, s62, 0x1
    s_lshl_b32 s51, s50, 15
    s_and_b32 s50, s62, 0xff22
    s_lshl_b32 s50, s50, 12
    s_or_b32 s51, s51, s50
    s_and_b32 s50, s62, 0x4
    s_lshl_b32 s50, s50, 14
    s_or_b32 s51, s51, s50
    s_and_b32 s50, s62, 0x8
    s_lshl_b32 s50, s50, 8
    s_or_b32 s51, s51, s50
    s_and_b32 s50, s62, 0x10
    s_lshl_b32 s50, s50, 6
    s_or_b32 s51, s51, s50
    s_and_b32 s50, s62, 0x40
    s_lshl_b32 s50, s50, 13
    s_or_b32 s51, s51, s50
    s_and_b32 s50, s62, 0x80
    s_lshl_b32 s50, s50, 11
    s_or_b32 s51, s51, s50
    s_mov_b32 s62, s51
L_nxd2:
    s_cmp_lg_u32 s66, 0
    s_cbranch_scc1 L_red2
L_redd2:
    v_cvt_pk_bf16_f32 v36, v32, v33
    v_cvt_pk_bf16_f32 v37, v34, v35
    s_lshr_b32 s50, s65, 7
    v_lshlrev_b32 v32, 16, v36
    v_and_b32 v33, 0xffff0000, v36
    v_lshlrev_b32 v34, 16, v37
    v_and_b32 v35, 0xffff0000, v37
    v_mul_f32 v32, 0x3db504f3, v32
    v_mul_f32 v33, 0x3db504f3, v33
    v_mul_f32 v34, 0x3db504f3, v34
    v_mul_f32 v35, 0x3db504f3, v35
    v_add_u32 v246, s50, v244
    v_cvt_pk_bf16_f32 v36, v32, v33
    v_cvt_pk_bf16_f32 v37, v34, v35
    v_max3_f32 v9, v9, v32, v33
    v_max3_f32 v9, v9, v34, v35
    s_mov_b64 exec, s[84:85]
    ds_write_b64 v246, v[36:37] offset:8192
    s_mov_b64 exec, -1
    s_cmp_eq_u32 s71, 0
    s_cbranch_scc1 L_kloop
    s_mov_b32 s71, 0
    v_mfma_f32_16x16x32_bf16 v[48:51], v[112:115], v[12:15], 0
    v_mfma_f32_16x16x32_bf16 v[52:55], v[116:119], v[12:15], 0
    v_mfma_f32_16x16x32_bf16 v[56:59], v[120:123], v[12:15], 0
    v_mfma_f32_16x16x32_bf16 v[60:63], v[124:127], v[12:15], 0
    s_nop 7
    v_mov_b32_dpp v32, v48 quad_perm:[0,0,0,0] row_mask:0xf bank_mask:0xf
    v_mov_b32_dpp v33, v52 quad_perm:[0,0,0,0] row_mask:0xf bank_mask:0xf
    v_mov_b32_dpp v34, v56 quad_perm:[0,0,0,0] row_mask:0xf bank_mask:0xf
    v_mov_b32_dpp v35, v60 quad_perm:[0,0,0,0] row_mask:0xf bank_mask:0xf
    v_add_f32_dpp v32, v49, v32 quad_perm:[1,1,1,1] row_mask:0xf bank_mask:0xf
    v_add_f32_dpp v33, v53, v33 quad_perm:[1,1,1,1] row_mask:0xf bank_mask:0xf
    v_add_f32_dpp v34, v57, v34 quad_perm:[1,1,1,1] row_mask:0xf bank_mask:0xf
    v_add_f32_dpp v35, v61, v35 quad_perm:[1,1,1,1] row_mask:0xf bank_mask:0xf
    v_add_f32_dpp v32, v50, v32 quad_perm:[2,2,2,2] row_mask:0xf bank_mask:0xf
    v_add_f32_dpp v33, v54, v33 quad_perm:[2,2,2,2] row_mask:0xf bank_mask:0xf
    v_add_f32_dpp v34, v58, v34 quad_perm:[2,2,2,2] row_mask:0xf bank_mask:0xf
    v_add_f32_dpp v35, v62, v35 quad_perm:[2,2,2,2] row_mask:0xf bank_mask:0xf
    v_add_f32_dpp v32, v51, v32 quad_perm:[3,3,3,3] row_mask:0xf bank_mask:0xf
    v_add_f32_dpp v33, v55, v33 quad_perm:[3,3,3,3] row_mask:0xf bank_mask:0xf
    v_add_f32_dpp v34, v59, v34 quad_perm:[3,3,3,3] row_mask:0xf bank_mask:0xf
    v_add_f32_dpp v35, v63, v35 quad_perm:[3,3,3,3] row_mask:0xf bank_mask:0xf
    v_cvt_pk_bf16_f32 v36, v32, v33
    v_cvt_pk_bf16_f32 v37, v34, v35
    s_lshr_b32 s50, s10, 7
    v_lshlrev_b32 v32, 16, v36
    v_and_b32 v33, 0xffff0000, v36
    v_lshlrev_b32 v34, 16, v37
    v_and_b32 v35, 0xffff0000, v37
    v_mul_f32 v32, 0x3db504f3, v32
    v_mul_f32 v33, 0x3db504f3, v33
    v_mul_f32 v34, 0x3db504f3, v34
    v_mul_f32 v35, 0x3db504f3, v35
    v_add_u32 v246, s50, v244
    v_cvt_pk_bf16_f32 v36, v32, v33
    v_cvt_pk_bf16_f32 v37, v34, v35
    v_max3_f32 v9, v9, v32, v33
    v_max3_f32 v9, v9, v34, v35
    s_mov_b64 exec, s[84:85]
    ds_write_b64 v246, v[36:37] offset:8192
    s_mov_b64 exec, -1
    v_mfma_f32_16x16x32_bf16 v[48:51], v[128:131], v[12:15], 0
    v_mfma_f32_16x16x32_bf16 v[52:55], v[132:135], v[12:15], 0
    v_mfma_f32_16x16x32_bf16 v[56:59], v[136:139], v[12:15], 0
    v_mfma_f32_16x16x32_bf16 v[60:63], v[140:143], v[12:15], 0
    s_nop 7
    v_mov_b32_dpp v32, v48 quad_perm:[0,0,0,0] row_mask:0xf bank_mask:0xf
    v_mov_b32_dpp v33, v52 quad_perm:[0,0,0,0] row_mask:0xf bank_mask:0xf
    v_mov_b32_dpp v34, v56 quad_perm:[0,0,0,0] row_mask:0xf bank_mask:0xf
    v_mov_b32_dpp v35, v60 quad_perm:[0,0,0,0] row_mask:0xf bank_mask:0xf
    v_add_f32_dpp v32, v49, v32 quad_perm:[1,1,1,1] row_mask:0xf bank_mask:0xf
    v_add_f32_dpp v33, v53, v33 quad_perm:[1,1,1,1] row_mask:0xf bank_mask:0xf
    v_add_f32_dpp v34, v57, v34 quad_perm:[1,1,1,1] row_mask:0xf bank_mask:0xf
    v_add_f32_dpp v35, v61, v35 quad_perm:[1,1,1,1] row_mask:0xf bank_mask:0xf
    v_add_f32_dpp v32, v50, v32 quad_perm:[2,2,2,2] row_mask:0xf bank_mask:0xf
    v_add_f32_dpp v33, v54, v33 quad_perm:[2,2,2,2] row_mask:0xf bank_mask:0xf
    v_add_f32_dpp v34, v58, v34 quad_perm:[2,2,2,2] row_mask:0xf bank_mask:0xf
    v_add_f32_dpp v35, v62, v35 quad_perm:[2,2,2,2] row_mask:0xf bank_mask:0xf
    v_add_f32_dpp v32, v51, v32 quad_perm:[3,3,3,3] row_mask:0xf bank_mask:0xf
    v_add_f32_dpp v33, v55, v33 quad_perm:[3,3,3,3] row_mask:0xf bank_mask:0xf
    v_add_f32_dpp v34, v59, v34 quad_perm:[3,3,3,3] row_mask:0xf bank_mask:0xf
    v_add_f32_dpp v35, v63, v35 quad_perm:[3,3,3,3] row_mask:0xf bank_mask:0xf
    v_cvt_pk_bf16_f32 v36, v32, v33
    v_cvt_pk_bf16_f32 v37, v34, v35
    s_lshr_b32 s50, s11, 7
    v_lshlrev_b32 v32, 16, v36
    v_and_b32 v33, 0xffff0000, v36
    v_lshlrev_b32 v34, 16, v37
    v_and_b32 v35, 0xffff0000, v37
    v_mul_f32 v32, 0x3db504f3, v32
    v_mul_f32 v33, 0x3db504f3, v33
    v_mul_f32 v34, 0x3db504f3, v34
    v_mul_f32 v35, 0x3db504f3, v35
    v_add_u32 v246, s50, v244
    v_cvt_pk_bf16_f32 v36, v32, v33
    v_cvt_pk_bf16_f32 v37, v34, v35
    v_max3_f32 v9, v9, v32, v33
    v_max3_f32 v9, v9, v34, v35
    s_mov_b64 exec, s[84:85]
    ds_write_b64 v246, v[36:37] offset:8192
    s_mov_b64 exec, -1
    v_mfma_f32_16x16x32_bf16 v[48:51], v[144:147], v[12:15], 0
    v_mfma_f32_16x16x32_bf16 v[52:55], v[148:151], v[12:15], 0
    v_mfma_f32_16x16x32_bf16 v[56:59], v[152:155], v[12:15], 0
    v_mfma_f32_16x16x32_bf16 v[60:63], v[156:159], v[12:15], 0
    s_nop 7
    v_mov_b32_dpp v32, v48 quad_perm:[0,0,0,0] row_mask:0xf bank_mask:0xf
    v_mov_b32_dpp v33, v52 quad_perm:[0,0,0,0] row_mask:0xf bank_mask:0xf
    v_mov_b32_dpp v34, v56 quad_perm:[0,0,0,0] row_mask:0xf bank_mask:0xf
    v_mov_b32_dpp v35, v60 quad_perm:[0,0,0,0] row_mask:0xf bank_mask:0xf
    v_add_f32_dpp v32, v49, v32 quad_perm:[1,1,1,1] row_mask:0xf bank_mask:0xf
    v_add_f32_dpp v33, v53, v33 quad_perm:[1,1,1,1] row_mask:0xf bank_mask:0xf
    v_add_f32_dpp v34, v57, v34 quad_perm:[1,1,1,1] row_mask:0xf bank_mask:0xf
    v_add_f32_dpp v35, v61, v35 quad_perm:[1,1,1,1] row_mask:0xf bank_mask:0xf
    v_add_f32_dpp v32, v50, v32 quad_perm:[2,2,2,2] row_mask:0xf bank_mask:0xf
    v_add_f32_dpp v33, v54, v33 quad_perm:[2,2,2,2] row_mask:0xf bank_mask:0xf
    v_add_f32_dpp v34, v58, v34 quad_perm:[2,2,2,2] row_mask:0xf bank_mask:0xf
    v_add_f32_dpp v35, v62, v35 quad_perm:[2,2,2,2] row_mask:0xf bank_mask:0xf
    v_add_f32_dpp v32, v51, v32 quad_perm:[3,3,3,3] row_mask:0xf bank_mask:0xf
    v_add_f32_dpp v33, v55, v33 quad_perm:[3,3,3,3] row_mask:0xf bank_mask:0xf
    v_add_f32_dpp v34, v59, v34 quad_perm:[3,3,3,3] row_mask:0xf bank_mask:0xf
    v_add_f32_dpp v35, v63, v35 quad_perm:[3,3,3,3] row_mask:0xf bank_mask:0xf
    v_cvt_pk_bf16_f32 v36, v32, v33
    v_cvt_pk_bf16_f32 v37, v34, v35
    s_lshr_b32 s50, s12, 7
    v_lshlrev_b32 v32, 16, v36
    v_and_b32 v33, 0xffff0000, v36
    v_lshlrev_b32 v34, 16, v37
    v_and_b32 v35, 0xffff0000, v37
    v_mul_f32 v32, 0x3db504f3, v32
    v_mul_f32 v33, 0x3db504f3, v33
    v_mul_f32 v34, 0x3db504f3, v34
    v_mul_f32 v35, 0x3db504f3, v35
    v_add_u32 v246, s50, v244
    v_cvt_pk_bf16_f32 v36, v32, v33
    v_cvt_pk_bf16_f32 v37, v34, v35
    v_max3_f32 v9, v9, v32, v33
    v_max3_f32 v9, v9, v34, v35
    s_mov_b64 exec, s[84:85]
    ds_write_b64 v246, v[36:37] offset:8192
    s_mov_b64 exec, -1
    v_mfma_f32_16x16x32_bf16 v[48:51], v[160:163], v[12:15], 0
    v_mfma_f32_16x16x32_bf16 v[52:55], v[164:167], v[12:15], 0
    v_mfma_f32_16x16x32_bf16 v[56:59], v[168:171], v[12:15], 0
    v_mfma_f32_16x16x32_bf16 v[60:63], v[172:175], v[12:15], 0
    s_nop 7
    v_mov_b32_dpp v32, v48 quad_perm:[0,0,0,0] row_mask:0xf bank_mask:0xf
    v_mov_b32_dpp v33, v52 quad_perm:[0,0,0,0] row_mask:0xf bank_mask:0xf
    v_mov_b32_dpp v34, v56 quad_perm:[0,0,0,0] row_mask:0xf bank_mask:0xf
    v_mov_b32_dpp v35, v60 quad_perm:[0,0,0,0] row_mask:0xf bank_mask:0xf
    v_add_f32_dpp v32, v49, v32 quad_perm:[1,1,1,1] row_mask:0xf bank_mask:0xf
    v_add_f32_dpp v33, v53, v33 quad_perm:[1,1,1,1] row_mask:0xf bank_mask:0xf
    v_add_f32_dpp v34, v57, v34 quad_perm:[1,1,1,1] row_mask:0xf bank_mask:0xf
    v_add_f32_dpp v35, v61, v35 quad_perm:[1,1,1,1] row_mask:0xf bank_mask:0xf
    v_add_f32_dpp v32, v50, v32 quad_perm:[2,2,2,2] row_mask:0xf bank_mask:0xf
    v_add_f32_dpp v33, v54, v33 quad_perm:[2,2,2,2] row_mask:0xf bank_mask:0xf
    v_add_f32_dpp v34, v58, v34 quad_perm:[2,2,2,2] row_mask:0xf bank_mask:0xf
    v_add_f32_dpp v35, v62, v35 quad_perm:[2,2,2,2] row_mask:0xf bank_mask:0xf
    v_add_f32_dpp v32, v51, v32 quad_perm:[3,3,3,3] row_mask:0xf bank_mask:0xf
    v_add_f32_dpp v33, v55, v33 quad_perm:[3,3,3,3] row_mask:0xf bank_mask:0xf
    v_add_f32_dpp v34, v59, v34 quad_perm:[3,3,3,3] row_mask:0xf bank_mask:0xf
    v_add_f32_dpp v35, v63, v35 quad_perm:[3,3,3,3] row_mask:0xf bank_mask:0xf
    v_cvt_pk_bf16_f32 v36, v32, v33
    v_cvt_pk_bf16_f32 v37, v34, v35
    s_lshr_b32 s50, s13, 7
    v_lshlrev_b32 v32, 16, v36
    v_and_b32 v33, 0xffff0000, v36
    v_lshlrev_b32 v34, 16, v37
    v_and_b32 v35, 0xffff0000, v37
    v_mul_f32 v32, 0x3db504f3, v32
    v_mul_f32 v33, 0x3db504f3, v33
    v_mul_f32 v34, 0x3db504f3, v34
    v_mul_f32 v35, 0x3db504f3, v35
    v_add_u32 v246, s50, v244
    v_cvt_pk_bf16_f32 v36, v32, v33
    v_cvt_pk_bf16_f32 v37, v34, v35
    v_max3_f32 v9, v9, v32, v33
    v_max3_f32 v9, v9, v34, v35
    s_mov_b64 exec, s[84:85]
    ds_write_b64 v246, v[36:37] offset:8192
    s_mov_b64 exec, -1
    v_mfma_f32_16x16x32_bf16 v[48:51], v[176:179], v[12:15], 0
    v_mfma_f32_16x16x32_bf16 v[52:55], v[180:183], v[12:15], 0
    v_mfma_f32_16x16x32_bf16 v[56:59], v[184:187], v[12:15], 0
    v_mfma_f32_16x16x32_bf16 v[60:63], v[188:191], v[12:15], 0
    s_nop 7
    v_mov_b32_dpp v32, v48 quad_perm:[0,0,0,0] row_mask:0xf bank_mask:0xf
    v_mov_b32_dpp v33, v52 quad_perm:[0,0,0,0] row_mask:0xf bank_mask:0xf
    v_mov_b32_dpp v34, v56 quad_perm:[0,0,0,0] row_mask:0xf bank_mask:0xf
    v_mov_b32_dpp v35, v60 quad_perm:[0,0,0,0] row_mask:0xf bank_mask:0xf
    v_add_f32_dpp v32, v49, v32 quad_perm:[1,1,1,1] row_mask:0xf bank_mask:0xf
    v_add_f32_dpp v33, v53, v33 quad_perm:[1,1,1,1] row_mask:0xf bank_mask:0xf
    v_add_f32_dpp v34, v57, v34 quad_perm:[1,1,1,1] row_mask:0xf bank_mask:0xf
    v_add_f32_dpp v35, v61, v35 quad_perm:[1,1,1,1] row_mask:0xf bank_mask:0xf
    v_add_f32_dpp v32, v50, v32 quad_perm:[2,2,2,2] row_mask:0xf bank_mask:0xf
    v_add_f32_dpp v33, v54, v33 quad_perm:[2,2,2,2] row_mask:0xf bank_mask:0xf
    v_add_f32_dpp v34, v58, v34 quad_perm:[2,2,2,2] row_mask:0xf bank_mask:0xf
    v_add_f32_dpp v35, v62, v35 quad_perm:[2,2,2,2] row_mask:0xf bank_mask:0xf
    v_add_f32_dpp v32, v51, v32 quad_perm:[3,3,3,3] row_mask:0xf bank_mask:0xf
    v_add_f32_dpp v33, v55, v33 quad_perm:[3,3,3,3] row_mask:0xf bank_mask:0xf
    v_add_f32_dpp v34, v59, v34 quad_perm:[3,3,3,3] row_mask:0xf bank_mask:0xf
    v_add_f32_dpp v35, v63, v35 quad_perm:[3,3,3,3] row_mask:0xf bank_mask:0xf
    v_cvt_pk_bf16_f32 v36, v32, v33
    v_cvt_pk_bf16_f32 v37, v34, v35
    s_lshr_b32 s50, s14, 7
    v_lshlrev_b32 v32, 16, v36
    v_and_b32 v33, 0xffff0000, v36
    v_lshlrev_b32 v34, 16, v37
    v_and_b32 v35, 0xffff0000, v37
    v_mul_f32 v32, 0x3db504f3, v32
    v_mul_f32 v33, 0x3db504f3, v33
    v_mul_f32 v34, 0x3db504f3, v34
    v_mul_f32 v35, 0x3db504f3, v35
    v_add_u32 v246, s50, v244
    v_cvt_pk_bf16_f32 v36, v32, v33
    v_cvt_pk_bf16_f32 v37, v34, v35
    v_max3_f32 v9, v9, v32, v33
    v_max3_f32 v9, v9, v34, v35
    s_mov_b64 exec, s[84:85]
    ds_write_b64 v246, v[36:37] offset:8192
    s_mov_b64 exec, -1
    s_branch L_kloop
L_qkb0:
    v_mfma_f32_16x16x32_bf16 v[48:51], v[64:67], v[12:15], 0
    v_mfma_f32_16x16x32_bf16 v[52:55], v[68:71], v[12:15], 0
    v_mfma_f32_16x16x32_bf16 v[56:59], v[72:75], v[12:15], 0
    v_mfma_f32_16x16x32_bf16 v[60:63], v[76:79], v[12:15], 0
    s_branch L_qkd0
L_ldb0:
    s_cmp_eq_u32 s64, 2
    s_cbranch_scc1 L_ldv0
    buffer_load_dwordx4 v[64:67], v6, s[32:35], s63 offen offset:0 nt
    buffer_load_dwordx4 v[68:71], v6, s[32:35], s63 offen offset:256 nt
    buffer_load_dwordx4 v[72:75], v6, s[32:35], s63 offen offset:512 nt
    buffer_load_dwordx4 v[76:79], v6, s[32:35], s63 offen offset:768 nt
    s_branch L_ldd0
L_ldv0:
    buffer_load_dwordx4 v[64:67], v5, s[36:39], s63 offen offset:0 nt
    buffer_load_dwordx4 v[68:71], v5, s[36:39], s63 offen offset:256 nt
    buffer_load_dwordx4 v[72:75], v5, s[36:39], s63 offen offset:512 nt
    buffer_load_dwordx4 v[76:79], v5, s[36:39], s63 offen offset:768 nt
    s_branch L_ldd0
L_nxv0:
    s_mov_b32 s64, 2
    s_and_b32 s50, s62, 0x1
    s_lshl_b32 s51, s50, 15
    s_and_b32 s50, s62, 0xff22
    s_lshl_b32 s50, s50, 12
    s_or_b32 s51, s51, s50
    s_and_b32 s50, s62, 0x14
    s_lshl_b32 s50, s50, 8
    s_or_b32 s51, s51, s50
    s_and_b32 s50, s62, 0x48
    s_lshl_b32 s50, s50, 13
    s_or_b32 s51, s51, s50
    s_and_b32 s50, s62, 0x80
    s_lshl_b32 s50, s50, 11
    s_or_b32 s51, s51, s50
    s_mov_b32 s62, s51
    s_branch L_nxd0
L_red0:
    v_mov_b32_dpp v32, v48 quad_perm:[0,0,0,0] row_mask:0xf bank_mask:0xf
    v_mov_b32_dpp v33, v52 quad_perm:[0,0,0,0] row_mask:0xf bank_mask:0xf
    v_mov_b32_dpp v34, v56 quad_perm:[0,0,0,0] row_mask:0xf bank_mask:0xf
    v_mov_b32_dpp v35, v60 quad_perm:[0,0,0,0] row_mask:0xf bank_mask:0xf
    v_add_f32_dpp v32, v49, v32 quad_perm:[1,1,1,1] row_mask:0xf bank_mask:0xf
    v_add_f32_dpp v33, v53, v33 quad_perm:[1,1,1,1] row_mask:0xf bank_mask:0xf
    v_add_f32_dpp v34, v57, v34 quad_perm:[1,1,1,1] row_mask:0xf bank_mask:0xf
    v_add_f32_dpp v35, v61, v35 quad_perm:[1,1,1,1] row_mask:0xf bank_mask:0xf
    v_add_f32_dpp v32, v50, v32 quad_perm:[2,2,2,2] row_mask:0xf bank_mask:0xf
    v_add_f32_dpp v33, v54, v33 quad_perm:[2,2,2,2] row_mask:0xf bank_mask:0xf
    v_add_f32_dpp v34, v58, v34 quad_perm:[2,2,2,2] row_mask:0xf bank_mask:0xf
    v_add_f32_dpp v35, v62, v35 quad_perm:[2,2,2,2] row_mask:0xf bank_mask:0xf
    v_add_f32_dpp v32, v51, v32 quad_perm:[3,3,3,3] row_mask:0xf bank_mask:0xf
    v_add_f32_dpp v33, v55, v33 quad_perm:[3,3,3,3] row_mask:0xf bank_mask:0xf
    v_add_f32_dpp v34, v59, v34 quad_perm:[3,3,3,3] row_mask:0xf bank_mask:0xf
    v_add_f32_dpp v35, v63, v35 quad_perm:[3,3,3,3] row_mask:0xf bank_mask:0xf
    s_branch L_redd0
L_venter0:
    s_mov_b32 s71, 0
    s_branch L_venter
L_qkb1:
    v_mfma_f32_16x16x32_bf16 v[48:51], v[80:83], v[12:15], 0
    v_mfma_f32_16x16x32_bf16 v[52:55], v[84:87], v[12:15], 0
    v_mfma_f32_16x16x32_bf16 v[56:59], v[88:91], v[12:15], 0
    v_mfma_f32_16x16x32_bf16 v[60:63], v[92:95], v[12:15], 0
    s_branch L_qkd1
L_ldb1:
    s_cmp_eq_u32 s64, 2
    s_cbranch_scc1 L_ldv1
    buffer_load_dwordx4 v[80:83], v6, s[32:35], s63 offen offset:0 nt
    buffer_load_dwordx4 v[84:87], v6, s[32:35], s63 offen offset:256 nt
    buffer_load_dwordx4 v[88:91], v6, s[32:35], s63 offen offset:512 nt
    buffer_load_dwordx4 v[92:95], v6, s[32:35], s63 offen offset:768 nt
    s_branch L_ldd1
L_ldv1:
    buffer_load_dwordx4 v[80:83], v5, s[36:39], s63 offen offset:0 nt
    buffer_load_dwordx4 v[84:87], v5, s[36:39], s63 offen offset:256 nt
    buffer_load_dwordx4 v[88:91], v5, s[36:39], s63 offen offset:512 nt
    buffer_load_dwordx4 v[92:95], v5, s[36:39], s63 offen offset:768 nt
    s_branch L_ldd1
L_nxv1:
    s_mov_b32 s64, 2
    s_and_b32 s50, s62, 0x1
    s_lshl_b32 s51, s50, 15
    s_and_b32 s50, s62, 0xff22
    s_lshl_b32 s50, s50, 12
    s_or_b32 s51, s51, s50
    s_and_b32 s50, s62, 0x14
    s_lshl_b32 s50, s50, 8
    s_or_b32 s51, s51, s50
    s_and_b32 s50, s62, 0x48
    s_lshl_b32 s50, s50, 13
    s_or_b32 s51, s51, s50
    s_and_b32 s50, s62, 0x80
    s_lshl_b32 s50, s50, 11
    s_or_b32 s51, s51, s50
    s_mov_b32 s62, s51
    s_branch L_nxd1
L_red1:
    v_mov_b32_dpp v32, v48 quad_perm:[0,0,0,0] row_mask:0xf bank_mask:0xf
    v_mov_b32_dpp v33, v52 quad_perm:[0,0,0,0] row_mask:0xf bank_mask:0xf
    v_mov_b32_dpp v34, v56 quad_perm:[0,0,0,0] row_mask:0xf bank_mask:0xf
    v_mov_b32_dpp v35, v60 quad_perm:[0,0,0,0] row_mask:0xf bank_mask:0xf
    v_add_f32_dpp v32, v49, v32 quad_perm:[1,1,1,1] row_mask:0xf bank_mask:0xf
    v_add_f32_dpp v33, v53, v33 quad_perm:[1,1,1,1] row_mask:0xf bank_mask:0xf
    v_add_f32_dpp v34, v57, v34 quad_perm:[1,1,1,1] row_mask:0xf bank_mask:0xf
    v_add_f32_dpp v35, v61, v35 quad_perm:[1,1,1,1] row_mask:0xf bank_mask:0xf
    v_add_f32_dpp v32, v50, v32 quad_perm:[2,2,2,2] row_mask:0xf bank_mask:0xf
    v_add_f32_dpp v33, v54, v33 quad_perm:[2,2,2,2] row_mask:0xf bank_mask:0xf
    v_add_f32_dpp v34, v58, v34 quad_perm:[2,2,2,2] row_mask:0xf bank_mask:0xf
    v_add_f32_dpp v35, v62, v35 quad_perm:[2,2,2,2] row_mask:0xf bank_mask:0xf
    v_add_f32_dpp v32, v51, v32 quad_perm:[3,3,3,3] row_mask:0xf bank_mask:0xf
    v_add_f32_dpp v33, v55, v33 quad_perm:[3,3,3,3] row_mask:0xf bank_mask:0xf
    v_add_f32_dpp v34, v59, v34 quad_perm:[3,3,3,3] row_mask:0xf bank_mask:0xf
    v_add_f32_dpp v35, v63, v35 quad_perm:[3,3,3,3] row_mask:0xf bank_mask:0xf
    s_branch L_redd1
L_venter1:
    s_mov_b32 s71, 1
    s_branch L_venter
L_qkb2:
    v_mfma_f32_16x16x32_bf16 v[48:51], v[96:99], v[12:15], 0
    v_mfma_f32_16x16x32_bf16 v[52:55], v[100:103], v[12:15], 0
    v_mfma_f32_16x16x32_bf16 v[56:59], v[104:107], v[12:15], 0
    v_mfma_f32_16x16x32_bf16 v[60:63], v[108:111], v[12:15], 0
    s_branch L_qkd2
L_ldb2:
    s_cmp_eq_u32 s64, 2
    s_cbranch_scc1 L_ldv2
    buffer_load_dwordx4 v[96:99], v6, s[32:35], s63 offen offset:0 nt
    buffer_load_dwordx4 v[100:103], v6, s[32:35], s63 offen offset:256 nt
    buffer_load_dwordx4 v[104:107], v6, s[32:35], s63 offen offset:512 nt
    buffer_load_dwordx4 v[108:111], v6, s[32:35], s63 offen offset:768 nt
    s_branch L_ldd2
L_ldv2:
    buffer_load_dwordx4 v[96:99], v5, s[36:39], s63 offen offset:0 nt
    buffer_load_dwordx4 v[100:103], v5, s[36:39], s63 offen offset:256 nt
    buffer_load_dwordx4 v[104:107], v5, s[36:39], s63 offen offset:512 nt
    buffer_load_dwordx4 v[108:111], v5, s[36:39], s63 offen offset:768 nt
    s_branch L_ldd2
L_nxv2:
    s_mov_b32 s64, 2
    s_and_b32 s50, s62, 0x1
    s_lshl_b32 s51, s50, 15
    s_and_b32 s50, s62, 0xff22
    s_lshl_b32 s50, s50, 12
    s_or_b32 s51, s51, s50
    s_and_b32 s50, s62, 0x14
    s_lshl_b32 s50, s50, 8
    s_or_b32 s51, s51, s50
    s_and_b32 s50, s62, 0x48
    s_lshl_b32 s50, s50, 13
    s_or_b32 s51, s51, s50
    s_and_b32 s50, s62, 0x80
    s_lshl_b32 s50, s50, 11
    s_or_b32 s51, s51, s50
    s_mov_b32 s62, s51
    s_branch L_nxd2
L_red2:
    v_mov_b32_dpp v32, v48 quad_perm:[0,0,0,0] row_mask:0xf bank_mask:0xf
    v_mov_b32_dpp v33, v52 quad_perm:[0,0,0,0] row_mask:0xf bank_mask:0xf
    v_mov_b32_dpp v34, v56 quad_perm:[0,0,0,0] row_mask:0xf bank_mask:0xf
    v_mov_b32_dpp v35, v60 quad_perm:[0,0,0,0] row_mask:0xf bank_mask:0xf
    v_add_f32_dpp v32, v49, v32 quad_perm:[1,1,1,1] row_mask:0xf bank_mask:0xf
    v_add_f32_dpp v33, v53, v33 quad_perm:[1,1,1,1] row_mask:0xf bank_mask:0xf
    v_add_f32_dpp v34, v57, v34 quad_perm:[1,1,1,1] row_mask:0xf bank_mask:0xf
    v_add_f32_dpp v35, v61, v35 quad_perm:[1,1,1,1] row_mask:0xf bank_mask:0xf
    v_add_f32_dpp v32, v50, v32 quad_perm:[2,2,2,2] row_mask:0xf bank_mask:0xf
    v_add_f32_dpp v33, v54, v33 quad_perm:[2,2,2,2] row_mask:0xf bank_mask:0xf
    v_add_f32_dpp v34, v58, v34 quad_perm:[2,2,2,2] row_mask:0xf bank_mask:0xf
    v_add_f32_dpp v35, v62, v35 quad_perm:[2,2,2,2] row_mask:0xf bank_mask:0xf
    v_add_f32_dpp v32, v51, v32 quad_perm:[3,3,3,3] row_mask:0xf bank_mask:0xf
    v_add_f32_dpp v33, v55, v33 quad_perm:[3,3,3,3] row_mask:0xf bank_mask:0xf
    v_add_f32_dpp v34, v59, v34 quad_perm:[3,3,3,3] row_mask:0xf bank_mask:0xf
    v_add_f32_dpp v35, v63, v35 quad_perm:[3,3,3,3] row_mask:0xf bank_mask:0xf
    s_branch L_redd2
L_venter2:
    s_mov_b32 s71, 2
    s_branch L_venter
L_venter:
    v_mov_b32 v242, v9
    s_nop 1
    v_permlane16_swap_b32 v242, v9
    s_nop 1
    v_max_f32 v9, v242, v9
    v_mov_b32 v242, v9
    s_nop 1
    v_permlane32_swap_b32 v242, v9
    s_nop 1
    v_max_f32 v9, v242, v9
    v_cvt_pk_bf16_f32 v9, v9, v9
    v_and_b32 v9, 0xffff0000, v9
    v_bfe_u32 v242, v1, 3, 1
    v_lshl_add_u32 v242, v242, 2, v240
    s_mov_b32 exec_lo, 0x101
    s_mov_b32 exec_hi, 0x0
    ds_max_f32 v242, v9 offset:36
    s_waitcnt lgkmcnt(0)
    s_mov_b64 exec, 1
    ds_add_u32 v240, v241 offset:32
    s_mov_b64 exec, -1
    s_mov_b32 s49, 8000000
L_kdone:
    ds_read_b32 v7, v240 offset:32
    s_sub_u32 s49, s49, 1
    s_cselect_b32 s50, 0, 4
    s_waitcnt lgkmcnt(0)
    v_readfirstlane_b32 s63, v7
    s_cmp_lt_u32 s63, s50
    s_cbranch_scc1 L_kdone
    ds_read_b32 v9, v242 offset:36
    s_waitcnt lgkmcnt(0)
    v_mul_f32 v10, s48, v9
    s_cmp_eq_u32 s71, 1
    s_cbranch_scc1 L_v1
    s_cmp_eq_u32 s71, 2
    s_cbranch_scc1 L_v2
L_vloop:
L_v0:
    s_cmp_ge_u32 s40, 2097152
    s_cbranch_scc1 L_done
    s_bfe_u32 s50, s40, 0xd0007
    v_add_u32 v246, s50, v245
    ds_read_b64 v[36:37], v246 offset:8192
    s_mov_b64 exec, 1
    ds_add_rtn_u32 v7, v240, v241
    ds_read_b64 v[252:253], v240 offset:44
    s_mov_b64 exec, -1
    s_mov_b32 s40, s62
    s_cmp_ge_u32 s62, 2097152
    s_cselect_b32 s38, 0, s38
    s_and_b32 s63, s62, 1048575
    s_lshr_b32 s50, s63, 11
    s_and_b32 s50, s50, 1
    s_lshl_b32 s50, s50, 20
    s_bitset0_b32 s63, 11
    s_or_b32 s63, s63, s50
    s_mov_b32 s66, s72
    s_mov_b32 s72, s64
    s_mov_b32 s65, s64
    s_waitcnt lgkmcnt(2)
    v_lshlrev_b32 v32, 16, v36
    v_and_b32 v33, 0xffff0000, v36
    v_lshlrev_b32 v34, 16, v37
    v_and_b32 v35, 0xffff0000, v37
    v_fma_f32 v32, v32, s48, -v10
    v_fma_f32 v33, v33, s48, -v10
    v_fma_f32 v34, v34, s48, -v10
    v_fma_f32 v35, v35, s48, -v10
    v_exp_f32 v32, v32
    v_exp_f32 v33, v33
    v_exp_f32 v34, v34
    v_exp_f32 v35, v35
    s_waitcnt lgkmcnt(0)
    v_readfirstlane_b32 s62, v7
    v_readfirstlane_b32 s68, v252
    v_readfirstlane_b32 s61, v253
    v_cvt_pk_bf16_f32 v36, v32, v32
    v_cvt_pk_bf16_f32 v37, v33, v33
    v_cvt_pk_bf16_f32 v38, v34, v34
    v_cvt_pk_bf16_f32 v39, v35, v35
    v_add_f32 v32, v32, v33
    v_add_f32 v34, v34, v35
    v_and_b32 v48, v36, v40
    v_and_b32 v49, v36, v41
    v_and_b32 v50, v36, v42
    v_and_b32 v51, v36, v43
    v_and_b32 v52, v37, v40
    v_and_b32 v53, v37, v41
    v_and_b32 v54, v37, v42
    v_and_b32 v55, v37, v43
    v_and_b32 v56, v38, v40
    v_and_b32 v57, v38, v41
    v_and_b32 v58, v38, v42
    v_and_b32 v59, v38, v43
    v_and_b32 v60, v39, v40
    v_and_b32 v61, v39, v41
    v_and_b32 v62, v39, v42
    v_and_b32 v63, v39, v43
    v_add_f32 v8, v8, v32
    v_add_f32 v8, v8, v34
    s_bfe_u32 s50, s62, 0x40002
    s_bitcmp1_b32 s69, s50
    s_cselect_b32 s64, 3, 2
    s_cmp_lt_u32 s62, s61
    s_cselect_b32 s64, 3, s64
    s_cmp_lt_u32 s62, s68
    s_cselect_b32 s64, 2, s64
    s_and_b32 s50, s62, 0x1
    s_lshl_b32 s51, s50, 15
    s_and_b32 s50, s62, 0xff22
    s_lshl_b32 s50, s50, 12
    s_or_b32 s51, s51, s50
    s_and_b32 s50, s62, 0x14
    s_lshl_b32 s50, s50, 8
    s_or_b32 s51, s51, s50
    s_and_b32 s50, s62, 0x48
    s_lshl_b32 s50, s50, 13
    s_or_b32 s51, s51, s50
    s_and_b32 s50, s62, 0x80
    s_lshl_b32 s50, s50, 11
    s_or_b32 s51, s51, s50
    s_mov_b32 s62, s51
    s_cmp_eq_u32 s66, 3
    s_waitcnt vmcnt(8)
    s_cbranch_scc1 L_vr0
    v_mfma_f32_16x16x32_bf16 v[44:47], v[48:51], v[64:67], v[44:47]
    v_mfma_f32_16x16x32_bf16 v[44:47], v[52:55], v[68:71], v[44:47]
    v_mfma_f32_16x16x32_bf16 v[44:47], v[56:59], v[72:75], v[44:47]
    v_mfma_f32_16x16x32_bf16 v[44:47], v[60:63], v[76:79], v[44:47]
L_vq0:
    s_cmp_eq_u32 s65, 3
    s_cbranch_scc1 L_vs0
    buffer_load_dwordx4 v[64:67], v5, s[36:39], s63 offen offset:0 nt
    buffer_load_dwordx4 v[68:71], v5, s[36:39], s63 offen offset:256 nt
    buffer_load_dwordx4 v[72:75], v5, s[36:39], s63 offen offset:512 nt
    buffer_load_dwordx4 v[76:79], v5, s[36:39], s63 offen offset:768 nt
L_vd0:
L_v1:
    s_cmp_ge_u32 s41, 2097152
    s_cbranch_scc1 L_done
    s_bfe_u32 s50, s41, 0xd0007
    v_add_u32 v246, s50, v245
    ds_read_b64 v[36:37], v246 offset:8192
    s_mov_b64 exec, 1
    ds_add_rtn_u32 v7, v240, v241
    ds_read_b64 v[252:253], v240 offset:44
    s_mov_b64 exec, -1
    s_mov_b32 s41, s62
    s_cmp_ge_u32 s62, 2097152
    s_cselect_b32 s38, 0, s38
    s_and_b32 s63, s62, 1048575
    s_lshr_b32 s50, s63, 11
    s_and_b32 s50, s50, 1
    s_lshl_b32 s50, s50, 20
    s_bitset0_b32 s63, 11
    s_or_b32 s63, s63, s50
    s_mov_b32 s66, s73
    s_mov_b32 s73, s64
    s_mov_b32 s65, s64
    s_waitcnt lgkmcnt(2)
    v_lshlrev_b32 v32, 16, v36
    v_and_b32 v33, 0xffff0000, v36
    v_lshlrev_b32 v34, 16, v37
    v_and_b32 v35, 0xffff0000, v37
    v_fma_f32 v32, v32, s48, -v10
    v_fma_f32 v33, v33, s48, -v10
    v_fma_f32 v34, v34, s48, -v10
    v_fma_f32 v35, v35, s48, -v10
    v_exp_f32 v32, v32
    v_exp_f32 v33, v33
    v_exp_f32 v34, v34
    v_exp_f32 v35, v35
    s_waitcnt lgkmcnt(0)
    v_readfirstlane_b32 s62, v7
    v_readfirstlane_b32 s68, v252
    v_readfirstlane_b32 s61, v253
    v_cvt_pk_bf16_f32 v36, v32, v32
    v_cvt_pk_bf16_f32 v37, v33, v33
    v_cvt_pk_bf16_f32 v38, v34, v34
    v_cvt_pk_bf16_f32 v39, v35, v35
    v_add_f32 v32, v32, v33
    v_add_f32 v34, v34, v35
    v_and_b32 v48, v36, v40
    v_and_b32 v49, v36, v41
    v_and_b32 v50, v36, v42
    v_and_b32 v51, v36, v43
    v_and_b32 v52, v37, v40
    v_and_b32 v53, v37, v41
    v_and_b32 v54, v37, v42
    v_and_b32 v55, v37, v43
    v_and_b32 v56, v38, v40
    v_and_b32 v57, v38, v41
    v_and_b32 v58, v38, v42
    v_and_b32 v59, v38, v43
    v_and_b32 v60, v39, v40
    v_and_b32 v61, v39, v41
    v_and_b32 v62, v39, v42
    v_and_b32 v63, v39, v43
    v_add_f32 v8, v8, v32
    v_add_f32 v8, v8, v34
    s_bfe_u32 s50, s62, 0x40002
    s_bitcmp1_b32 s69, s50
    s_cselect_b32 s64, 3, 2
    s_cmp_lt_u32 s62, s61
    s_cselect_b32 s64, 3, s64
    s_cmp_lt_u32 s62, s68
    s_cselect_b32 s64, 2, s64
    s_and_b32 s50, s62, 0x1
    s_lshl_b32 s51, s50, 15
    s_and_b32 s50, s62, 0xff22
    s_lshl_b32 s50, s50, 12
    s_or_b32 s51, s51, s50
    s_and_b32 s50, s62, 0x14
    s_lshl_b32 s50, s50, 8
    s_or_b32 s51, s51, s50
    s_and_b32 s50, s62, 0x48
    s_lshl_b32 s50, s50, 13
    s_or_b32 s51, s51, s50
    s_and_b32 s50, s62, 0x80
    s_lshl_b32 s50, s50, 11
    s_or_b32 s51, s51, s50
    s_mov_b32 s62, s51
    s_cmp_eq_u32 s66, 3
    s_waitcnt vmcnt(8)
    s_cbranch_scc1 L_vr1
    v_mfma_f32_16x16x32_bf16 v[44:47], v[48:51], v[80:83], v[44:47]
    v_mfma_f32_16x16x32_bf16 v[44:47], v[52:55], v[84:87], v[44:47]
    v_mfma_f32_16x16x32_bf16 v[44:47], v[56:59], v[88:91], v[44:47]
    v_mfma_f32_16x16x32_bf16 v[44:47], v[60:63], v[92:95], v[44:47]
L_vq1:
    s_cmp_eq_u32 s65, 3
    s_cbranch_scc1 L_vs1
    buffer_load_dwordx4 v[80:83], v5, s[36:39], s63 offen offset:0 nt
    buffer_load_dwordx4 v[84:87], v5, s[36:39], s63 offen offset:256 nt
    buffer_load_dwordx4 v[88:91], v5, s[36:39], s63 offen offset:512 nt
    buffer_load_dwordx4 v[92:95], v5, s[36:39], s63 offen offset:768 nt
L_vd1:
L_v2:
    s_cmp_ge_u32 s42, 2097152
    s_cbranch_scc1 L_done
    s_bfe_u32 s50, s42, 0xd0007
    v_add_u32 v246, s50, v245
    ds_read_b64 v[36:37], v246 offset:8192
    s_mov_b64 exec, 1
    ds_add_rtn_u32 v7, v240, v241
    ds_read_b64 v[252:253], v240 offset:44
    s_mov_b64 exec, -1
    s_mov_b32 s42, s62
    s_cmp_ge_u32 s62, 2097152
    s_cselect_b32 s38, 0, s38
    s_and_b32 s63, s62, 1048575
    s_lshr_b32 s50, s63, 11
    s_and_b32 s50, s50, 1
    s_lshl_b32 s50, s50, 20
    s_bitset0_b32 s63, 11
    s_or_b32 s63, s63, s50
    s_mov_b32 s66, s74
    s_mov_b32 s74, s64
    s_mov_b32 s65, s64
    s_waitcnt lgkmcnt(2)
    v_lshlrev_b32 v32, 16, v36
    v_and_b32 v33, 0xffff0000, v36
    v_lshlrev_b32 v34, 16, v37
    v_and_b32 v35, 0xffff0000, v37
    v_fma_f32 v32, v32, s48, -v10
    v_fma_f32 v33, v33, s48, -v10
    v_fma_f32 v34, v34, s48, -v10
    v_fma_f32 v35, v35, s48, -v10
    v_exp_f32 v32, v32
    v_exp_f32 v33, v33
    v_exp_f32 v34, v34
    v_exp_f32 v35, v35
    s_waitcnt lgkmcnt(0)
    v_readfirstlane_b32 s62, v7
    v_readfirstlane_b32 s68, v252
    v_readfirstlane_b32 s61, v253
    v_cvt_pk_bf16_f32 v36, v32, v32
    v_cvt_pk_bf16_f32 v37, v33, v33
    v_cvt_pk_bf16_f32 v38, v34, v34
    v_cvt_pk_bf16_f32 v39, v35, v35
    v_add_f32 v32, v32, v33
    v_add_f32 v34, v34, v35
    v_and_b32 v48, v36, v40
    v_and_b32 v49, v36, v41
    v_and_b32 v50, v36, v42
    v_and_b32 v51, v36, v43
    v_and_b32 v52, v37, v40
    v_and_b32 v53, v37, v41
    v_and_b32 v54, v37, v42
    v_and_b32 v55, v37, v43
    v_and_b32 v56, v38, v40
    v_and_b32 v57, v38, v41
    v_and_b32 v58, v38, v42
    v_and_b32 v59, v38, v43
    v_and_b32 v60, v39, v40
    v_and_b32 v61, v39, v41
    v_and_b32 v62, v39, v42
    v_and_b32 v63, v39, v43
    v_add_f32 v8, v8, v32
    v_add_f32 v8, v8, v34
    s_bfe_u32 s50, s62, 0x40002
    s_bitcmp1_b32 s69, s50
    s_cselect_b32 s64, 3, 2
    s_cmp_lt_u32 s62, s61
    s_cselect_b32 s64, 3, s64
    s_cmp_lt_u32 s62, s68
    s_cselect_b32 s64, 2, s64
    s_and_b32 s50, s62, 0x1
    s_lshl_b32 s51, s50, 15
    s_and_b32 s50, s62, 0xff22
    s_lshl_b32 s50, s50, 12
    s_or_b32 s51, s51, s50
    s_and_b32 s50, s62, 0x14
    s_lshl_b32 s50, s50, 8
    s_or_b32 s51, s51, s50
    s_and_b32 s50, s62, 0x48
    s_lshl_b32 s50, s50, 13
    s_or_b32 s51, s51, s50
    s_and_b32 s50, s62, 0x80
    s_lshl_b32 s50, s50, 11
    s_or_b32 s51, s51, s50
    s_mov_b32 s62, s51
    s_cmp_eq_u32 s66, 3
    s_waitcnt vmcnt(8)
    s_cbranch_scc1 L_vr2
    v_mfma_f32_16x16x32_bf16 v[44:47], v[48:51], v[96:99], v[44:47]
    v_mfma_f32_16x16x32_bf16 v[44:47], v[52:55], v[100:103], v[44:47]
    v_mfma_f32_16x16x32_bf16 v[44:47], v[56:59], v[104:107], v[44:47]
    v_mfma_f32_16x16x32_bf16 v[44:47], v[60:63], v[108:111], v[44:47]
L_vq2:
    s_cmp_eq_u32 s65, 3
    s_cbranch_scc1 L_vs2
    buffer_load_dwordx4 v[96:99], v5, s[36:39], s63 offen offset:0 nt
    buffer_load_dwordx4 v[100:103], v5, s[36:39], s63 offen offset:256 nt
    buffer_load_dwordx4 v[104:107], v5, s[36:39], s63 offen offset:512 nt
    buffer_load_dwordx4 v[108:111], v5, s[36:39], s63 offen offset:768 nt
L_vd2:
    s_branch L_vloop
L_vs0:
    buffer_load_dwordx4 v[64:67], v248, s[36:39], s63 offen nt
    buffer_load_dwordx4 v[68:71], v249, s[36:39], s63 offen nt
    buffer_load_dwordx4 v[72:75], v250, s[36:39], s63 offen nt
    buffer_load_dwordx4 v[76:79], v251, s[36:39], s63 offen nt
    s_branch L_vd0
L_vr0:
    v_cndmask_b32 v208, v64, v76, s[90:91]
    v_cndmask_b32 v209, v65, v77, s[90:91]
    v_cndmask_b32 v210, v66, v78, s[90:91]
    v_cndmask_b32 v211, v67, v79, s[90:91]
    v_cndmask_b32 v212, v68, v64, s[90:91]
    v_cndmask_b32 v213, v69, v65, s[90:91]
    v_cndmask_b32 v214, v70, v66, s[90:91]
    v_cndmask_b32 v215, v71, v67, s[90:91]
    v_cndmask_b32 v216, v72, v68, s[90:91]
    v_cndmask_b32 v217, v73, v69, s[90:91]
    v_cndmask_b32 v218, v74, v70, s[90:91]
    v_cndmask_b32 v219, v75, v71, s[90:91]
    v_cndmask_b32 v220, v76, v72, s[90:91]
    v_cndmask_b32 v221, v77, v73, s[90:91]
    v_cndmask_b32 v222, v78, v74, s[90:91]
    v_cndmask_b32 v223, v79, v75, s[90:91]
    v_cndmask_b32 v224, v208, v216, s[88:89]
    v_cndmask_b32 v225, v209, v217, s[88:89]
    v_cndmask_b32 v226, v210, v218, s[88:89]
    v_cndmask_b32 v227, v211, v219, s[88:89]
    v_cndmask_b32 v228, v212, v220, s[88:89]
    v_cndmask_b32 v229, v213, v221, s[88:89]
    v_cndmask_b32 v230, v214, v222, s[88:89]
    v_cndmask_b32 v231, v215, v223, s[88:89]
    v_cndmask_b32 v232, v216, v208, s[88:89]
    v_cndmask_b32 v233, v217, v209, s[88:89]
    v_cndmask_b32 v234, v218, v210, s[88:89]
    v_cndmask_b32 v235, v219, v211, s[88:89]
    v_cndmask_b32 v236, v220, v212, s[88:89]
    v_cndmask_b32 v237, v221, v213, s[88:89]
    v_cndmask_b32 v238, v222, v214, s[88:89]
    v_cndmask_b32 v239, v223, v215, s[88:89]
    s_nop 1
    v_mfma_f32_16x16x32_bf16 v[44:47], v[48:51], v[224:227], v[44:47]
    v_mfma_f32_16x16x32_bf16 v[44:47], v[52:55], v[228:231], v[44:47]
    v_mfma_f32_16x16x32_bf16 v[44:47], v[56:59], v[232:235], v[44:47]
    v_mfma_f32_16x16x32_bf16 v[44:47], v[60:63], v[236:239], v[44:47]
    s_branch L_vq0
L_vs1:
    buffer_load_dwordx4 v[80:83], v248, s[36:39], s63 offen nt
    buffer_load_dwordx4 v[84:87], v249, s[36:39], s63 offen nt
    buffer_load_dwordx4 v[88:91], v250, s[36:39], s63 offen nt
    buffer_load_dwordx4 v[92:95], v251, s[36:39], s63 offen nt
    s_branch L_vd1
L_vr1:
    v_cndmask_b32 v208, v80, v92, s[90:91]
    v_cndmask_b32 v209, v81, v93, s[90:91]
    v_cndmask_b32 v210, v82, v94, s[90:91]
    v_cndmask_b32 v211, v83, v95, s[90:91]
    v_cndmask_b32 v212, v84, v80, s[90:91]
    v_cndmask_b32 v213, v85, v81, s[90:91]
    v_cndmask_b32 v214, v86, v82, s[90:91]
    v_cndmask_b32 v215, v87, v83, s[90:91]
    v_cndmask_b32 v216, v88, v84, s[90:91]
    v_cndmask_b32 v217, v89, v85, s[90:91]
    v_cndmask_b32 v218, v90, v86, s[90:91]
    v_cndmask_b32 v219, v91, v87, s[90:91]
    v_cndmask_b32 v220, v92, v88, s[90:91]
    v_cndmask_b32 v221, v93, v89, s[90:91]
    v_cndmask_b32 v222, v94, v90, s[90:91]
    v_cndmask_b32 v223, v95, v91, s[90:91]
    v_cndmask_b32 v224, v208, v216, s[88:89]
    v_cndmask_b32 v225, v209, v217, s[88:89]
    v_cndmask_b32 v226, v210, v218, s[88:89]
    v_cndmask_b32 v227, v211, v219, s[88:89]
    v_cndmask_b32 v228, v212, v220, s[88:89]
    v_cndmask_b32 v229, v213, v221, s[88:89]
    v_cndmask_b32 v230, v214, v222, s[88:89]
    v_cndmask_b32 v231, v215, v223, s[88:89]
    v_cndmask_b32 v232, v216, v208, s[88:89]
    v_cndmask_b32 v233, v217, v209, s[88:89]
    v_cndmask_b32 v234, v218, v210, s[88:89]
    v_cndmask_b32 v235, v219, v211, s[88:89]
    v_cndmask_b32 v236, v220, v212, s[88:89]
    v_cndmask_b32 v237, v221, v213, s[88:89]
    v_cndmask_b32 v238, v222, v214, s[88:89]
    v_cndmask_b32 v239, v223, v215, s[88:89]
    s_nop 1
    v_mfma_f32_16x16x32_bf16 v[44:47], v[48:51], v[224:227], v[44:47]
    v_mfma_f32_16x16x32_bf16 v[44:47], v[52:55], v[228:231], v[44:47]
    v_mfma_f32_16x16x32_bf16 v[44:47], v[56:59], v[232:235], v[44:47]
    v_mfma_f32_16x16x32_bf16 v[44:47], v[60:63], v[236:239], v[44:47]
    s_branch L_vq1
L_vs2:
    buffer_load_dwordx4 v[96:99], v248, s[36:39], s63 offen nt
    buffer_load_dwordx4 v[100:103], v249, s[36:39], s63 offen nt
    buffer_load_dwordx4 v[104:107], v250, s[36:39], s63 offen nt
    buffer_load_dwordx4 v[108:111], v251, s[36:39], s63 offen nt
    s_branch L_vd2
L_vr2:
    v_cndmask_b32 v208, v96, v108, s[90:91]
    v_cndmask_b32 v209, v97, v109, s[90:91]
    v_cndmask_b32 v210, v98, v110, s[90:91]
    v_cndmask_b32 v211, v99, v111, s[90:91]
    v_cndmask_b32 v212, v100, v96, s[90:91]
    v_cndmask_b32 v213, v101, v97, s[90:91]
    v_cndmask_b32 v214, v102, v98, s[90:91]
    v_cndmask_b32 v215, v103, v99, s[90:91]
    v_cndmask_b32 v216, v104, v100, s[90:91]
    v_cndmask_b32 v217, v105, v101, s[90:91]
    v_cndmask_b32 v218, v106, v102, s[90:91]
    v_cndmask_b32 v219, v107, v103, s[90:91]
    v_cndmask_b32 v220, v108, v104, s[90:91]
    v_cndmask_b32 v221, v109, v105, s[90:91]
    v_cndmask_b32 v222, v110, v106, s[90:91]
    v_cndmask_b32 v223, v111, v107, s[90:91]
    v_cndmask_b32 v224, v208, v216, s[88:89]
    v_cndmask_b32 v225, v209, v217, s[88:89]
    v_cndmask_b32 v226, v210, v218, s[88:89]
    v_cndmask_b32 v227, v211, v219, s[88:89]
    v_cndmask_b32 v228, v212, v220, s[88:89]
    v_cndmask_b32 v229, v213, v221, s[88:89]
    v_cndmask_b32 v230, v214, v222, s[88:89]
    v_cndmask_b32 v231, v215, v223, s[88:89]
    v_cndmask_b32 v232, v216, v208, s[88:89]
    v_cndmask_b32 v233, v217, v209, s[88:89]
    v_cndmask_b32 v234, v218, v210, s[88:89]
    v_cndmask_b32 v235, v219, v211, s[88:89]
    v_cndmask_b32 v236, v220, v212, s[88:89]
    v_cndmask_b32 v237, v221, v213, s[88:89]
    v_cndmask_b32 v238, v222, v214, s[88:89]
    v_cndmask_b32 v239, v223, v215, s[88:89]
    s_nop 1
    v_mfma_f32_16x16x32_bf16 v[44:47], v[48:51], v[224:227], v[44:47]
    v_mfma_f32_16x16x32_bf16 v[44:47], v[52:55], v[228:231], v[44:47]
    v_mfma_f32_16x16x32_bf16 v[44:47], v[56:59], v[232:235], v[44:47]
    v_mfma_f32_16x16x32_bf16 v[44:47], v[60:63], v[236:239], v[44:47]
    s_branch L_vq2
L_done:
    v_mov_b32 v12, v8
    s_mul_i32 s61, s31, 1056
    v_lshl_add_u32 v16, v1, 4, s61
    v_permlane16_swap_b32 v12, v8
    v_and_b32 v13, 8, v1
    v_add_u32 v13, s61, v13
    v_add_f32 v8, v8, v12
    v_mov_b32 v12, v8
    v_mov_b32 v14, v10
    ds_write_b128 v16, v[44:47] offset:2560
    v_permlane32_swap_b32 v12, v8
    v_lshlrev_b32 v16, 4, v1
    v_lshrrev_b32 v17, 5, v1
    v_add_f32 v15, v8, v12
    ds_write_b64 v13, v[14:15] offset:3584
    v_lshlrev_b32 v14, 3, v17
    v_lshlrev_b32 v12, 9, v17
    v_lshl_add_u32 v12, v2, 5, v12
    v_and_b32 v15, 16, v1
    v_add_u32 v12, v12, v15
    s_lshl_b32 s64, s30, 11
    s_add_u32 s64, s64, 65536
    s_movk_i32 s60, 0x3ff
    v_mov_b32 v42, s97
    v_mov_b32 v43, s97
    s_waitcnt lgkmcnt(0)
    s_mov_b64 exec, 1
    ds_add_rtn_u32 v7, v240, v241 offset:20
    s_mov_b64 exec, -1
    s_waitcnt lgkmcnt(0)
    v_readfirstlane_b32 s61, v7
    s_cmp_eq_u32 s61, 3
    s_cbranch_scc1 L_m_merge
    s_cmp_lg_u32 s61, 0
    s_cbranch_scc1 L_final
    s_cmp_eq_u32 s99, -1
    s_cbranch_scc1 L_final
    s_mov_b32 s49, 8000000
L_yrdy:
    ds_read_b32 v7, v240 offset:28
    s_sub_u32 s49, s49, 1
    s_cselect_b32 s50, 0, 1
    s_waitcnt lgkmcnt(0)
    v_readfirstlane_b32 s61, v7
    s_cmp_lt_u32 s61, s50
    s_cbranch_scc1 L_yrdy
    s_mov_b32 exec_lo, 0xffff
    s_mov_b32 exec_hi, 0x0
    ds_read_b128 v[20:23], v16 offset:7936
    s_lshl_b32 s65, s99, 4
    s_add_u32 s65, s65, s28
    s_lshl_b32 s65, s65, 11
    s_add_u32 s65, s65, 1048576
    s_waitcnt lgkmcnt(0)
    buffer_store_dwordx4 v[20:23], v16, s[52:55], s65 offen offset:1024 sc1
    s_mov_b64 exec, -1
    s_branch L_final
L_m_merge:
    ds_read_b64 v[32:33], v14 offset:3584
    ds_read_b64 v[34:35], v14 offset:4640
    ds_read_b64 v[36:37], v14 offset:5696
    ds_read_b64 v[38:39], v14 offset:6752
    ds_read_b128 v[20:23], v16 offset:2560
    ds_read_b128 v[24:27], v16 offset:3616
    ds_read_b128 v[28:31], v16 offset:4672
    ds_read_b128 v[48:51], v16 offset:5728
    v_lshlrev_b32 v14, 1, v14
    s_waitcnt lgkmcnt(4)
    v_mov_b32 v40, v32
    v_add_f32 v33, v33, v35
    v_add_f32 v37, v37, v39
    s_waitcnt lgkmcnt(2)
    v_pk_add_f32 v[44:45], v[20:21], v[24:25]
    v_pk_add_f32 v[46:47], v[22:23], v[26:27]
    v_add_f32 v41, v33, v37
    s_waitcnt lgkmcnt(0)
    v_pk_add_f32 v[28:29], v[28:29], v[48:49]
    v_pk_add_f32 v[30:31], v[30:31], v[50:51]
    v_pk_add_f32 v[44:45], v[44:45], v[28:29]
    v_pk_add_f32 v[46:47], v[46:47], v[30:31]
    v_bfi_b32 v44, s60, v42, v44
    v_bfi_b32 v45, s60, v42, v45
    v_bfi_b32 v46, s60, v42, v46
    v_bfi_b32 v47, s60, v42, v47
    s_cmp_eq_u32 s70, 0
    s_cbranch_scc1 L_m_plain
    buffer_store_dwordx4 v[44:47], v12, s[52:55], s64 offen sc1
    s_mov_b32 exec_lo, 0x1
    s_mov_b32 exec_hi, 0x1
    buffer_store_dwordx4 v[40:43], v14, s[52:55], s64 offen offset:1024 sc1
    s_branch L_m_pub
L_m_plain:
    buffer_store_dwordx4 v[44:47], v12, s[52:55], s64 offen
    s_mov_b32 exec_lo, 0x1
    s_mov_b32 exec_hi, 0x1
    buffer_store_dwordx4 v[40:43], v14, s[52:55], s64 offen offset:1024
L_m_pub:
    ds_write_b32 v240, v241 offset:24
    s_mov_b64 exec, -1
L_final:
    s_lshl_b32 s61, s30, 2
    s_add_u32 s61, s61, s31
    s_cmp_lg_u32 s61, 960
    s_cbranch_scc1 L_noep
    v_lshlrev_b32 v5, 11, v2
    s_mov_b32 s63, 1048576
    s_mov_b32 s49, 2000000
L_ep_poll:
    buffer_load_dwordx4 v[8:11], v5, s[52:55], s63 offen offset:1024 sc1
    s_sub_u32 s49, s49, 1
    s_cbranch_scc1 L_ep_ok
    s_waitcnt vmcnt(0)
    v_xor_b32 v28, s97, v8
    v_bitop3_b32 v28, v28, v9, s97 bitop3:0xf6
    v_bitop3_b32 v28, v28, v10, s97 bitop3:0xf6
    v_bitop3_b32 v28, v28, v11, s97 bitop3:0xf6
    v_and_b32 v28, 0x3ff, v28
    v_cmp_ne_u32 vcc, 0, v28
    s_cbranch_vccz L_ep_ok
    s_sleep 4
    s_branch L_ep_poll
L_ep_ok:
    v_mov_b32 v9, s97
    v_mov_b32 v10, 32768
    s_mov_b64 exec, 1
    s_waitcnt vmcnt(0)
    buffer_store_dword v9, v10, s[52:55], 0 offen sc1
    s_mov_b64 exec, -1
L_noep:
    s_cmp_lg_u32 s28, s99
    s_cbranch_scc1 L_fin
    s_mov_b32 s40, s4
    s_mov_b32 s41, s5
    s_mov_b32 s42, 1152
    s_mov_b32 s43, 0x20000
    s_mov_b32 s56, s22
    s_mov_b32 s57, s23
    s_mov_b32 s58, 1152
    s_mov_b32 s59, 0x20000
    v_lshlrev_b32 v5, 4, v2
    v_lshl_add_u32 v5, v3, 11, v5
    v_lshl_add_u32 v7, v2, 2, v3
    s_lshl_b32 s61, s99, 6
    v_add_u32 v6, s61, v7
    v_lshlrev_b32 v6, 1, v6
    v_lshlrev_b32 v7, 2, v7
    v_mov_b32 v26, 0
    s_lshl_b32 s63, s99, 15
    s_add_u32 s44, s63, 1048576
    s_add_u32 s45, s44, 8192
    s_add_u32 s46, s44, 16384
    s_add_u32 s47, s44, 24576
    s_lshl_b32 s61, s31, 13
    s_add_u32 s63, s44, s61
    buffer_load_short_d16_hi v26, v6, s[40:43], 0 offen
    s_lshl_b32 s61, s31, 8
    v_add_u32 v25, s61, v7
    v_mov_b32 v30, 1564
    v_mov_b32 v31, 1
    s_mov_b32 s49, 2000000
L_fy_poll:
    buffer_load_dwordx4 v[8:11], v5, s[52:55], s44 offen offset:1024 sc1
    buffer_load_dwordx4 v[12:15], v5, s[52:55], s45 offen offset:1024 sc1
    buffer_load_dwordx4 v[16:19], v5, s[52:55], s46 offen offset:1024 sc1
    buffer_load_dwordx4 v[20:23], v5, s[52:55], s47 offen offset:1024 sc1
    s_sub_u32 s49, s49, 1
    s_cbranch_scc1 L_fy_poll_ok
    s_waitcnt vmcnt(3)
    v_xor_b32 v28, s97, v8
    v_bitop3_b32 v28, v28, v9, s97 bitop3:0xf6
    v_bitop3_b32 v28, v28, v10, s97 bitop3:0xf6
    v_bitop3_b32 v28, v28, v11, s97 bitop3:0xf6
    s_waitcnt vmcnt(2)
    v_xor_b32 v29, s97, v12
    v_bitop3_b32 v29, v29, v13, s97 bitop3:0xf6
    v_bitop3_b32 v29, v29, v14, s97 bitop3:0xf6
    v_bitop3_b32 v29, v29, v15, s97 bitop3:0xf6
    s_waitcnt vmcnt(1)
    v_bitop3_b32 v28, v28, v16, s97 bitop3:0xf6
    v_bitop3_b32 v28, v28, v17, s97 bitop3:0xf6
    v_bitop3_b32 v28, v28, v18, s97 bitop3:0xf6
    v_bitop3_b32 v28, v28, v19, s97 bitop3:0xf6
    s_waitcnt vmcnt(0)
    v_bitop3_b32 v29, v29, v20, s97 bitop3:0xf6
    v_bitop3_b32 v29, v29, v21, s97 bitop3:0xf6
    v_bitop3_b32 v29, v29, v22, s97 bitop3:0xf6
    v_bitop3_b32 v29, v29, v23, s97 bitop3:0xf6
    v_or_b32 v28, v28, v29
    v_and_b32 v28, 0x3ff, v28
    v_cmp_ne_u32 vcc, 0, v28
    s_and_b64 exec, exec, vcc
    s_cbranch_execz L_fy_poll_ok
    s_sleep 4
    s_branch L_fy_poll
L_fy_poll_ok:
    s_mov_b64 exec, -1
    s_waitcnt vmcnt(0)
    v_pk_add_f32 v[8:9], v[8:9], v[12:13]
    v_pk_add_f32 v[16:17], v[16:17], v[20:21]
    v_pk_add_f32 v[10:11], v[10:11], v[14:15]
    v_pk_add_f32 v[18:19], v[18:19], v[22:23]
    v_pk_add_f32 v[8:9], v[8:9], v[16:17]
    v_pk_add_f32 v[10:11], v[10:11], v[18:19]
    s_nop 1
    v_permlane16_swap_b32 v8, v9
    v_permlane16_swap_b32 v10, v11
    s_nop 0
    v_add_f32 v8, v8, v9
    v_add_f32 v10, v10, v11
    s_nop 1
    v_permlane32_swap_b32 v8, v10
    s_nop 0
    v_add_f32 v8, v8, v10
    v_mov_b32 v27, v8
    v_cvt_pk_bf16_f32 v27, v27, v27
    v_and_b32 v27, 0xffff0000, v27
    v_mul_f32 v13, 0xbfb8aa3b, v27
    v_exp_f32 v13, v13
    s_nop 0
    v_add_f32 v13, 1.0, v13
    v_rcp_f32 v13, v13
    s_nop 0
    v_mul_f32 v27, v27, v13
    v_cvt_pk_bf16_f32 v27, v27, v27
    v_and_b32 v27, 0xffff0000, v27
    s_mov_b32 s49, 2000000
L_f_poll:
    buffer_load_dwordx4 v[8:11], v5, s[52:55], s63 offen sc1
    s_sub_u32 s49, s49, 1
    s_cbranch_scc1 L_f_ok
    s_waitcnt vmcnt(0)
    v_xor_b32 v28, s97, v8
    v_bitop3_b32 v28, v28, v9, s97 bitop3:0xf6
    v_bitop3_b32 v28, v28, v10, s97 bitop3:0xf6
    v_bitop3_b32 v28, v28, v11, s97 bitop3:0xf6
    v_and_b32 v28, 0x3ff, v28
    v_cmp_ne_u32 vcc, 0, v28
    s_and_b64 exec, exec, vcc
    s_cbranch_execnz L_f_poll
L_f_ok:
    s_mov_b64 exec, -1
    s_waitcnt vmcnt(0)
    v_permlane16_swap_b32 v8, v9
    v_permlane16_swap_b32 v10, v11
    s_nop 0
    v_add_f32 v8, v8, v9
    v_add_f32 v10, v10, v11
    s_nop 1
    v_permlane32_swap_b32 v8, v10
    s_nop 0
    v_add_f32 v8, v8, v10
    ds_write_b32 v25, v8 offset:0
    s_waitcnt lgkmcnt(0)
    s_mov_b64 exec, 1
    ds_add_rtn_u32 v9, v30, v31
    s_mov_b64 exec, -1
    s_waitcnt lgkmcnt(0)
    v_readfirstlane_b32 s61, v9
    s_cmp_lg_u32 s61, 3
    s_cbranch_scc1 L_fin
    ds_read2st64_b32 v[8:9], v7 offset0:0 offset1:1
    ds_read2st64_b32 v[10:11], v7 offset0:2 offset1:3
    s_waitcnt lgkmcnt(0)
    v_pk_add_f32 v[8:9], v[8:9], v[10:11]
    v_add_f32 v8, v8, v9
    v_cvt_pk_bf16_f32 v8, v8, v8
    v_and_b32 v8, 0xffff0000, v8
    v_mul_f32 v8, v8, v27
    v_cvt_pk_bf16_f32 v8, v8, v8
    v_and_b32 v8, 0xffff0000, v8
    v_add_f32 v8, v8, v26
    v_cvt_pk_bf16_f32 v8, v8, v8
    buffer_store_short v8, v6, s[56:59], 0 offen
L_fin:
L_end:
    s_endpgm
.section .rodata,"a"
.p2align 6
.amdhsa_kernel recurrent_scan__gqa_block_cached__glu_gated_glu__decode_kernel
  .amdhsa_next_free_vgpr 256
  .amdhsa_next_free_sgpr 102
  .amdhsa_accum_offset 256
  .amdhsa_group_segment_fixed_size 0
  .amdhsa_kernarg_size 96
  .amdhsa_user_sgpr_count 2
  .amdhsa_user_sgpr_kernarg_segment_ptr 1
  .amdhsa_system_sgpr_workgroup_id_x 1
.end_amdhsa_kernel
```
